```python
import torch

def _softmax(x, axis=-1):
    return torch.softmax(x, dim=axis)
def _gelu(x):
    return torch.nn.functional.gelu(x, approximate="tanh")
def _silu(x):
    return torch.nn.functional.silu(x)
def _sigmoid(x):
    return torch.sigmoid(x)
def _layernorm(x, axis=-1, eps=1e-5):
    m = x.mean(dim=axis, keepdim=True)
    v = x.var(dim=axis, keepdim=True, unbiased=False)
    return (x - m) / torch.sqrt(v + eps)
def _scatter_add(tgt, idx, src, axis=0):
    return tgt.clone().index_add_(axis, idx, src)
def _segment_sum(src, seg, n):
    out = torch.zeros((n,) + src.shape[1:], dtype=src.dtype)
    return out.index_add_(0, seg, src)
def _pad(x, pw):
    flat = tuple(v for pair in reversed(pw) for v in pair)
    return torch.nn.functional.pad(x, flat)

kernel_name = 'gated_mix__linear_attn_block__dense_activation_squared_relu__prompt'

def setup_inputs():

    _w = (lambda a: (lambda t: t.to(torch.bfloat16) if t.is_floating_point() else t)(torch.as_tensor(a)))
    def _A_setup():
        B, S, D = 1, 2048, 512
        return {
            "x": _w((lambda *s: torch.randn(*s, dtype=torch.bfloat16) * 0.05)(B, S, D)),
            "wqkv": _w((lambda *s: torch.randn(*s, dtype=torch.bfloat16) * 0.8)(D, 3 * D)),
            "wo": _w((lambda *s: torch.randn(*s, dtype=torch.bfloat16) * 0.2)(D, D)),
        }
    _A_in = _A_setup()

    def _B_setup():
        B, S, D, F = 1, 2048, 512, 1792
        return {
            "x": _w((lambda *s: torch.randn(*s, dtype=torch.bfloat16) * 0.05)(B, S, D)),
            "w1": _w((lambda *s: torch.randn(*s, dtype=torch.bfloat16) * 0.1)(D, F)),
            "b1": _w((lambda *s: torch.randn(*s, dtype=torch.bfloat16) * 0.05)(F)),
            "w2": _w((lambda *s: torch.randn(*s, dtype=torch.bfloat16) * 0.05)(F, D)),
            "b2": _w((lambda *s: torch.randn(*s, dtype=torch.bfloat16) * 0.05)(D)),
        }
    _B_in = _B_setup()

    return {
        "A_x": _A_in["x"],
        "A_wqkv": _A_in["wqkv"],
        "A_wo": _A_in["wo"],
        "B_x": _B_in["x"],
        "B_w1": _B_in["w1"],
        "B_b1": _B_in["b1"],
        "B_w2": _B_in["w2"],
        "B_b2": _B_in["b2"],
        "gate_w": _w((lambda *s: torch.randn(*s, dtype=torch.bfloat16) * 0.05)(512) * 16.0),
    }

def reference(A_x, A_wqkv, A_wo, B_x, B_w1, B_b1, B_w2, B_b2, gate_w):
    def _A_ref(x, wqkv, wo):
        B, S, D = x.shape
        H = 32; Dh = D // H
        qkv = (lambda x, *d: x.permute(*d))((x @ wqkv).reshape(B, S, 3, H, Dh), 2, 0, 3, 1, 4)
        q, k, v = qkv[0], qkv[1], qkv[2]
        phi = lambda t: torch.where(t > 0, t + 1, torch.exp(t)) + 1e-6
        pq, pk = phi(q), phi(k)
        kv = torch.einsum("bhsd,bhse->bhde", pk, v)
        z = torch.einsum("bhsd->bhd", pk)
        num = torch.einsum("bhqd,bhde->bhqe", pq, kv)
        den = torch.einsum("bhqd,bhd->bhq", pq, z)[..., None] + 1e-6
        o = num / den
        return (lambda x, *d: x.permute(*d))(o, 0, 2, 1, 3).reshape(B, S, D) @ wo

    def _B_ref(x, w1, b1, w2, b2):
        h = torch.einsum("bsd,df->bsf", x, w1) + b1
        zero = torch.zeros_like(h)
        r = torch.where(h > zero, h, zero)
        h = r * r
        out = torch.einsum("bsf,fd->bsd", h, w2) + b2
        return out

    x = A_x
    g = _sigmoid((x * gate_w).sum(-1, keepdims=True))
    a = _A_ref(x, A_wqkv, A_wo)
    b = _B_ref(x, B_w1, B_b1, B_w2, B_b2)
    return g * a + (1 - g) * b
```

```asm
; @launch grid=(256,1,1) block=(256,1,1) lds=163840
.amdgcn_target "amdgcn-amd-amdhsa--gfx950"
.text
.globl gated_mix__linear_attn_block__dense_activation_squared_relu__prompt_kernel
.p2align 8
.type gated_mix__linear_attn_block__dense_activation_squared_relu__prompt_kernel,@function
gated_mix__linear_attn_block__dense_activation_squared_relu__prompt_kernel:
    s_lshr_b32 s99, s2, 8
    s_cbranch_scc1 L_end
    s_load_dwordx16 s[64:79], s[0:1], 0
    s_load_dwordx8 s[80:87], s[0:1], 64
    v_readfirstlane_b32 s42, v0
    v_lshrrev_b32 v3, 4, v0
    v_xor_b32 v3, v3, v0
    v_and_b32 v3, 7, v3
    v_lshlrev_b32 v3, 4, v3
    v_lshrrev_b32 v2, 3, v0
    v_lshl_or_b32 v2, v2, 10, v3
    s_lshr_b32 s54, s2, 3
    s_and_b32 s45, s2, 1
    s_and_b32 s99, s54, 7
    s_lshl3_add_u32 s45, s45, s99
    s_lshr_b32 s49, s2, 6
    s_xor_b32 s52, s45, s49
    s_lshl2_add_u32 s52, s52, s2
    s_mov_b32 s7, 0x20000
    s_lshl_b32 s6, s7, 4
    s_lshr_b32 s97, s7, 2
    s_lshl_b32 s63, s42, 4
    s_lshl_b32 s56, s45, 10
    s_getpc_b64 s[100:101]
L_pc:
    s_mul_i32 s99, s54, 12
    v_min_u32 v248, 11, v0
    v_add_lshl_u32 v248, v248, s99, 7
    v_min_u32 v248, L_end-L_pc, v248
    v_add_co_u32 v248, vcc, s100, v248
    v_mov_b32 v249, s101
    s_mov_b32 m0, s63
    v_addc_co_u32 v249, vcc, 0, v249, vcc
    global_load_dword v253, v[248:249], off
    s_and_b32 s53, s52, 7
    s_add_u32 s50, s56, s53
    s_lshl_b32 s50, s50, 7
    s_bitcmp1_b32 s2, 6
    s_waitcnt lgkmcnt(0)
    s_mov_b64 s[4:5], s[64:65]
    s_cselect_b64 s[8:9], s[72:73], s[66:67]
    global_load_dword v253, v3, s[8:9]
    buffer_load_dwordx4 v2, s[4:7], s50 offen lds
    s_addk_i32 m0, 0x1000
    s_add_u32 s50, s50, s97
    buffer_load_dwordx4 v2, s[4:7], s50 offen lds
    s_addk_i32 m0, 0x1000
    s_add_u32 s50, s50, s97
    buffer_load_dwordx4 v2, s[4:7], s50 offen lds
    s_addk_i32 m0, 0x1000
    s_add_u32 s50, s50, s97
    buffer_load_dwordx4 v2, s[4:7], s50 offen lds
L_p256:
    s_mov_b32 s11, s7
    s_bfe_u32 s48, s2, 0x20001
    s_lshl2_add_u32 s46, s48, s49
    s_lshr_b32 s47, s46, 1
    s_and_b32 s54, s47, 1
    s_mul_i32 s57, s47, 7
    s_mul_i32 s99, s54, 3
    s_add_u32 s57, s57, s99
    s_lshl1_add_u32 s99, s47, 16
    s_bitcmp1_b32 s2, 6
    s_cselect_b32 s57, s57, s99
    s_cselect_b32 s96, 7, 6
    s_cselect_b32 s97, 7, 10
    s_lshl_b32 s57, s57, 6
    s_lshl_b32 s10, s96, 18
    s_lshl_b32 s96, s96, 9
    v_and_b32 v1, 63, v0
    v_bfe_u32 v242, v0, 2, 2
    s_lshr_b32 s99, s42, 4
    v_add_u32 v242, s99, v242
    v_and_b32 v243, 3, v0
    v_lshlrev_b32 v243, 4, v243
    v_lshrrev_b32 v241, 4, v1
    v_and_b32 v244, 1, v241
    v_lshl_add_u32 v244, v244, 6, v243
    v_lshrrev_b32 v240, 5, v1
    v_lshl_add_u32 v244, v240, s97, v244
    v_mul_u32_u24 v6, s96, v242
    s_mul_i32 s51, s53, s96
    s_lshl_b32 s51, s51, 6
    s_lshr_b32 s99, s7, 1
    s_add_u32 m0, s63, s99
    v_add3_u32 v6, v6, v244, s57
    s_lshl_b32 s99, s96, 4
    buffer_load_dwordx4 v6, s[8:11], s51 offen lds
    s_addk_i32 m0, 0x1000
    v_add_u32 v7, s99, v6
    buffer_load_dwordx4 v7, s[8:11], s51 offen lds
    s_addk_i32 m0, 0x1000
    v_add_u32 v8, s99, v7
    buffer_load_dwordx4 v8, s[8:11], s51 offen lds
    s_addk_i32 m0, 0x1000
    v_add_u32 v9, s99, v8
    buffer_load_dwordx4 v9, s[8:11], s51 offen lds
L_p512:
    s_lshr_b32 s42, s42, 6
    s_lshr_b32 s43, s42, 1
    s_and_b32 s44, s42, 1
    s_lshl_b32 s55, s42, 12
    v_lshlrev_b32 v34, 4, v1
    s_mul_i32 s99, s42, 12
    v_add_u32 v242, s99, v242
    s_lshl1_add_u32 s13, s45, s43
    s_lshl3_add_u32 s13, s13, s47
    s_lshl1_add_u32 s13, s13, s44
    s_lshl_b32 s12, s13, 12
    s_bitcmp1_b32 s2, 6
    s_cbranch_scc1 L_nog
    global_load_dwordx4 v[176:179], v34, s[80:81]
    buffer_load_dwordx4 v[160:163], v34, s[4:7], s12 offen offset:0
    buffer_load_dwordx4 v[164:167], v34, s[4:7], s12 offen offset:1024
    buffer_load_dwordx4 v[168:171], v34, s[4:7], s12 offen offset:2048
    buffer_load_dwordx4 v[172:175], v34, s[4:7], s12 offen offset:3072
L_nog:
    s_cmp_lg_u32 s48, 1
    s_cbranch_scc1 L_nop3
    s_lshr_b32 s99, s2, 3
    s_lshl2_add_u32 s99, s99, s42
    s_mul_i32 s99, s99, 12
    v_min_u32 v245, 11, v1
    v_add_lshl_u32 v245, v245, s99, 10
    global_load_dword v253, v245, s[66:67] offset:384
L_nop3:
    v_add_u32 v3, 0x8000, v2
    v_add_u32 v4, 0x10000, v2
    v_add_u32 v5, 0x18000, v2
    s_mov_b64 s[24:25], s[86:87]
    s_mov_b32 s26, 0x1400000
    s_mov_b32 s27, 0x20000
    s_mov_b64 s[16:17], s[68:69]
    s_mov_b32 s18, 0x80000
    s_mov_b32 s19, 0x20000
    s_mov_b64 s[20:21], s[76:77]
    s_mov_b32 s22, 0x1c0000
    s_mov_b32 s23, 0x20000
    s_mov_b64 s[28:29], s[82:83]
    s_mov_b32 s30, 0x200000
    s_mov_b32 s31, 0x20000
    s_mov_b64 s[36:37], s[74:75]
    s_mov_b64 s[38:39], s[78:79]
    s_mov_b64 s[40:41], s[84:85]
    s_bitcmp1_b32 s2, 6
    s_cbranch_scc0 L_A
    s_lshr_b32 s99, s2, 3
    s_cmp_lg_u32 s99, 8
    s_cbranch_scc1 L_noinit
    v_min_u32 v245, 15, v1
    v_lshlrev_b32 v245, 8, v245
    v_mov_b32 v246, 0
    s_and_b32 s99, s2, 7
    s_lshl2_add_u32 s99, s99, s42
    s_lshl_b32 s99, s99, 12
    s_add_u32 s99, s99, 0x1200000
    buffer_store_dword v246, v245, s[24:27], s99 offen sc1
L_noinit:
    s_branch L_Q
L_A:
    s_mov_b32 s0, 1
    s_mov_b32 s1, 0x10000
    s_mov_b32 s98, 0x40000
    s_add_u32 s53, s52, 1
    s_and_b32 s53, s53, 7
    s_lshl_b32 s50, s45, 10
    s_add_u32 s50, s50, s53
    s_lshl_b32 s50, s50, 7
    s_mul_i32 s51, s53, 196608
    s_add_u32 m0, s63, 16384
    s_nop 0
    buffer_load_dwordx4 v2, s[4:7], s50 offen lds
    s_add_u32 m0, s63, 81920
    s_nop 0
    buffer_load_dwordx4 v6, s[8:11], s51 offen lds
    s_add_u32 m0, s63, 20480
    s_nop 0
    buffer_load_dwordx4 v3, s[4:7], s50 offen lds
    s_add_u32 m0, s63, 86016
    s_nop 0
    buffer_load_dwordx4 v7, s[8:11], s51 offen lds
    s_add_u32 m0, s63, 24576
    v_lshrrev_b32 v245, 5, v1
    v_and_b32 v246, 31, v1
    v_lshlrev_b32 v35, 2, v246
    v_mov_b32 v254, 0xffff0000
    v_bfe_u32 v240, v246, 1, 3
    v_xor_b32 v240, v240, v245
    v_lshlrev_b32 v240, 4, v240
    v_lshl_add_u32 v240, v246, 7, v240
    v_add_u32 v14, s55, v240
    v_xor_b32 v18, 0x1000, v14
    v_xor_b32 v15, 32, v14
    v_xor_b32 v16, 64, v14
    v_xor_b32 v17, 96, v14
    v_xor_b32 v19, 32, v18
    v_xor_b32 v20, 64, v18
    v_xor_b32 v21, 96, v18
    v_bfe_u32 v240, v1, 2, 2
    v_lshlrev_b32 v244, 6, v240
    v_and_b32 v240, 1, v241
    v_lshl_add_u32 v244, v240, 5, v244
    v_lshrrev_b32 v240, 1, v243
    v_add_u32 v244, v244, v240
    v_lshl_add_u32 v240, v245, 11, v244
    s_lshl_b32 s99, s44, 8
    s_add_u32 s99, s99, 0x10000
    v_add_u32 v22, s99, v240
    v_lshl_add_u32 v23, v245, 10, v244
    s_lshl_b32 s99, s44, 9
    v_add_u32 v23, s99, v23
    v_add_u32 v24, 0x10000, v23
    v_lshl_add_u32 v29, v245, 10, v244
    v_add_u32 v30, 0x10000, v29
    v_add_u32 v31, 0x20000, v29
    v_bfe_u32 v240, v1, 2, 3
    s_lshl_b32 s99, s42, 4
    v_add_u32 v240, s99, v240
    v_mul_u32_u24 v10, 3072, v240
    v_lshl_add_u32 v244, v245, 6, v243
    s_lshl_b32 s99, s47, 7
    v_add3_u32 v10, v10, v244, s99
    v_add_u32 v11, 24576, v10
    v_add_u32 v240, s48, v241
    v_and_b32 v240, 3, v240
    v_lshl_add_u32 v244, v240, 6, v243
    v_bfe_u32 v240, v1, 2, 2
    v_lshl_add_u32 v240, v240, 10, v244
    s_lshl_b32 s99, s49, 8
    s_add_u32 s99, s99, s55
    v_add_u32 v27, s99, v240
    s_lshl_b32 s62, s45, 3
    s_add_u32 s62, s62, s47
    s_lshl_b32 s62, s62, 2
    s_add_u32 s62, s62, s42
    s_mul_i32 s99, s62, 28
    v_min_u32 v240, 27, v1
    v_add_u32 v240, s99, v240
    v_lshlrev_b32 v250, 7, v240
    s_mul_i32 s99, s62, 8
    v_min_u32 v240, 7, v1
    v_add_u32 v240, s99, v240
    v_lshlrev_b32 v13, 7, v240
    s_lshr_b32 s99, s45, 2
    s_mul_i32 s99, s99, 2424832
    s_and_b32 s56, s45, 3
    s_lshl_b32 s56, s56, 2
    s_add_u32 s56, s56, s42
    s_lshl_b32 s56, s56, 10
    s_add_u32 s99, s99, s56
    s_add_u32 s99, s99, 0x10000
    v_add_u32 v32, s99, v34
    v_xor_b32 v33, 0x400, v32
    s_mul_i32 s56, s48, 458752
    s_lshl_b32 s57, s48, 17
    s_lshl_b32 s99, s13, 4
    s_add_u32 s99, s99, 0x9e0000
    v_cmp_eq_u32 vcc, 63, v1
    v_mov_b32 v240, s99
    v_mov_b32 v244, 0x7fffff00
    v_cndmask_b32 v28, v244, v240, vcc
    s_lshl_b32 s99, s45, 1
    s_add_u32 s15, s99, s43
    s_lshl_b32 s58, s15, 2
    s_lshr_b32 s97, s46, 2
    s_add_u32 s58, s58, s97
    s_lshl_b32 s59, s47, 1
    s_add_u32 s59, s59, s44
    s_lshl_b32 s59, s59, 2
    s_lshl_b32 s62, s45, 2
    s_add_u32 s62, s62, s49
    s_lshl_b32 s61, s62, 2
    s_add_u32 s61, s61, s42
    s_lshl_b32 s62, s62, 4
    s_add_u32 s62, s62, s42
    s_mul_i32 s62, s62, 6144
    s_add_u32 s62, s62, 0xa00000
    s_lshl_b32 s58, s58, 8
    s_add_u32 s58, s58, 0x1200000
    s_lshl_b32 s59, s59, 8
    s_add_u32 s59, s59, 0x121b000
    s_lshl_b32 s61, s61, 8
    s_add_u32 s61, s61, 0x120b000
    s_lshl_b32 s15, s15, 8
    s_add_u32 s15, s15, 0x1209000
    v_mov_b32 v252, 0x3fb8aa3b
    v_mov_b32 v251, 0x358637bd
    buffer_load_dwordx4 v4, s[4:7], s50 offen lds
    s_add_u32 m0, s63, 90112
    s_nop 0
    buffer_load_dwordx4 v8, s[8:11], s51 offen lds
    s_add_u32 m0, s63, 28672
    s_waitcnt vmcnt(6)
    v_lshlrev_b32 v180, 16, v176
    v_and_b32 v181, v254, v176
    v_lshlrev_b32 v182, 16, v177
    v_and_b32 v183, v254, v177
    v_lshlrev_b32 v184, 16, v178
    v_and_b32 v185, v254, v178
    v_lshlrev_b32 v186, 16, v179
    v_and_b32 v187, v254, v179
    v_lshlrev_b32 v188, 16, v160
    v_and_b32 v189, v254, v160
    v_lshlrev_b32 v190, 16, v161
    v_and_b32 v191, v254, v161
    v_lshlrev_b32 v192, 16, v162
    v_and_b32 v193, v254, v162
    v_lshlrev_b32 v194, 16, v163
    buffer_load_dwordx4 v5, s[4:7], s50 offen lds
    s_add_u32 m0, s63, 94208
    v_and_b32 v195, v254, v163
    v_mul_f32 v188, v188, v180
    v_mul_f32 v189, v189, v181
    v_mul_f32 v190, v190, v182
    v_mul_f32 v191, v191, v183
    v_mul_f32 v192, v192, v184
    v_mul_f32 v193, v193, v185
    v_mul_f32 v194, v194, v186
    v_mul_f32 v195, v195, v187
    v_cvt_pk_bf16_f32 v160, v188, v189
    v_cvt_pk_bf16_f32 v161, v190, v191
    v_cvt_pk_bf16_f32 v162, v192, v193
    v_cvt_pk_bf16_f32 v163, v194, v195
    v_lshlrev_b32 v188, 16, v160
    v_and_b32 v189, v254, v160
    v_lshlrev_b32 v190, 16, v161
    buffer_load_dwordx4 v9, s[8:11], s51 offen lds
    s_add_u32 s53, s52, 2
    s_and_b32 s53, s53, 7
    s_lshl_b32 s50, s45, 10
    s_add_u32 s50, s50, s53
    s_lshl_b32 s50, s50, 7
    s_mul_i32 s51, s53, 196608
    s_add_u32 m0, s63, 32768
    v_and_b32 v191, v254, v161
    v_lshlrev_b32 v192, 16, v162
    v_and_b32 v193, v254, v162
    v_lshlrev_b32 v194, 16, v163
    v_and_b32 v195, v254, v163
    v_add_f32 v188, v188, v192
    v_add_f32 v189, v189, v193
    v_add_f32 v190, v190, v194
    v_add_f32 v191, v191, v195
    v_add_f32 v188, v188, v190
    v_add_f32 v189, v189, v191
    v_add_f32 v36, v188, v189
    v_lshlrev_b32 v188, 16, v164
    v_and_b32 v189, v254, v164
    v_lshlrev_b32 v190, 16, v165
    v_and_b32 v191, v254, v165
    buffer_load_dwordx4 v2, s[4:7], s50 offen lds
    s_add_u32 m0, s63, 98304
    v_lshlrev_b32 v192, 16, v166
    v_and_b32 v193, v254, v166
    v_lshlrev_b32 v194, 16, v167
    v_and_b32 v195, v254, v167
    v_mul_f32 v188, v188, v180
    v_mul_f32 v189, v189, v181
    v_mul_f32 v190, v190, v182
    v_mul_f32 v191, v191, v183
    v_mul_f32 v192, v192, v184
    v_mul_f32 v193, v193, v185
    v_mul_f32 v194, v194, v186
    v_mul_f32 v195, v195, v187
    v_cvt_pk_bf16_f32 v164, v188, v189
    v_cvt_pk_bf16_f32 v165, v190, v191
    v_cvt_pk_bf16_f32 v166, v192, v193
    v_cvt_pk_bf16_f32 v167, v194, v195
    buffer_load_dwordx4 v6, s[8:11], s51 offen lds
    s_add_u32 m0, s63, 36864
    v_lshlrev_b32 v188, 16, v164
    v_and_b32 v189, v254, v164
    v_lshlrev_b32 v190, 16, v165
    v_and_b32 v191, v254, v165
    v_lshlrev_b32 v192, 16, v166
    v_and_b32 v193, v254, v166
    v_lshlrev_b32 v194, 16, v167
    v_and_b32 v195, v254, v167
    v_add_f32 v188, v188, v192
    v_add_f32 v189, v189, v193
    v_add_f32 v190, v190, v194
    v_add_f32 v191, v191, v195
    v_add_f32 v188, v188, v190
    v_add_f32 v189, v189, v191
    v_add_f32 v37, v188, v189
    v_lshlrev_b32 v188, 16, v168
    buffer_load_dwordx4 v3, s[4:7], s50 offen lds
    s_add_u32 m0, s63, 102400
    v_and_b32 v189, v254, v168
    v_lshlrev_b32 v190, 16, v169
    v_and_b32 v191, v254, v169
    v_lshlrev_b32 v192, 16, v170
    v_and_b32 v193, v254, v170
    v_lshlrev_b32 v194, 16, v171
    v_and_b32 v195, v254, v171
    v_mul_f32 v188, v188, v180
    v_mul_f32 v189, v189, v181
    v_mul_f32 v190, v190, v182
    v_mul_f32 v191, v191, v183
    v_mul_f32 v192, v192, v184
    v_mul_f32 v193, v193, v185
    v_mul_f32 v194, v194, v186
    v_mul_f32 v195, v195, v187
    v_cvt_pk_bf16_f32 v168, v188, v189
    buffer_load_dwordx4 v7, s[8:11], s51 offen lds
    s_add_u32 m0, s63, 40960
    v_cvt_pk_bf16_f32 v169, v190, v191
    v_cvt_pk_bf16_f32 v170, v192, v193
    v_cvt_pk_bf16_f32 v171, v194, v195
    v_lshlrev_b32 v188, 16, v168
    v_and_b32 v189, v254, v168
    v_lshlrev_b32 v190, 16, v169
    v_and_b32 v191, v254, v169
    v_lshlrev_b32 v192, 16, v170
    v_and_b32 v193, v254, v170
    v_lshlrev_b32 v194, 16, v171
    v_and_b32 v195, v254, v171
    v_add_f32 v188, v188, v192
    v_add_f32 v189, v189, v193
    v_add_f32 v190, v190, v194
    v_add_f32 v191, v191, v195
    v_add_f32 v188, v188, v190
    buffer_load_dwordx4 v4, s[4:7], s50 offen lds
    s_add_u32 m0, s63, 106496
    v_add_f32 v189, v189, v191
    v_add_f32 v38, v188, v189
    v_lshlrev_b32 v188, 16, v172
    v_and_b32 v189, v254, v172
    v_lshlrev_b32 v190, 16, v173
    v_and_b32 v191, v254, v173
    v_lshlrev_b32 v192, 16, v174
    v_and_b32 v193, v254, v174
    v_lshlrev_b32 v194, 16, v175
    v_and_b32 v195, v254, v175
    v_mul_f32 v188, v188, v180
    v_mul_f32 v189, v189, v181
    v_mul_f32 v190, v190, v182
    v_mul_f32 v191, v191, v183
    v_mul_f32 v192, v192, v184
    v_mul_f32 v193, v193, v185
    buffer_load_dwordx4 v8, s[8:11], s51 offen lds
    s_add_u32 m0, s63, 45056
    v_mul_f32 v194, v194, v186
    v_mul_f32 v195, v195, v187
    v_cvt_pk_bf16_f32 v172, v188, v189
    v_cvt_pk_bf16_f32 v173, v190, v191
    v_cvt_pk_bf16_f32 v174, v192, v193
    v_cvt_pk_bf16_f32 v175, v194, v195
    v_lshlrev_b32 v188, 16, v172
    v_and_b32 v189, v254, v172
    v_lshlrev_b32 v190, 16, v173
    v_and_b32 v191, v254, v173
    v_lshlrev_b32 v192, 16, v174
    v_and_b32 v193, v254, v174
    v_lshlrev_b32 v194, 16, v175
    v_and_b32 v195, v254, v175
    v_add_f32 v188, v188, v192
    v_add_f32 v189, v189, v193
    buffer_load_dwordx4 v5, s[4:7], s50 offen lds
    s_add_u32 m0, s63, 110592
    v_add_f32 v190, v190, v194
    v_add_f32 v191, v191, v195
    v_add_f32 v188, v188, v190
    v_add_f32 v189, v189, v191
    v_add_f32 v39, v188, v189
    v_add_f32_dpp v36, v36, v36 row_shr:1 row_mask:0xf bank_mask:0xf
    v_add_f32_dpp v37, v37, v37 row_shr:1 row_mask:0xf bank_mask:0xf
    v_add_f32_dpp v38, v38, v38 row_shr:1 row_mask:0xf bank_mask:0xf
    v_add_f32_dpp v39, v39, v39 row_shr:1 row_mask:0xf bank_mask:0xf
    v_add_f32_dpp v36, v36, v36 row_shr:2 row_mask:0xf bank_mask:0xf
    v_add_f32_dpp v37, v37, v37 row_shr:2 row_mask:0xf bank_mask:0xf
    v_add_f32_dpp v38, v38, v38 row_shr:2 row_mask:0xf bank_mask:0xf
    v_add_f32_dpp v39, v39, v39 row_shr:2 row_mask:0xf bank_mask:0xf
    v_add_f32_dpp v36, v36, v36 row_shr:4 row_mask:0xf bank_mask:0xf
    v_add_f32_dpp v37, v37, v37 row_shr:4 row_mask:0xf bank_mask:0xf
    v_add_f32_dpp v38, v38, v38 row_shr:4 row_mask:0xf bank_mask:0xf
    buffer_load_dwordx4 v9, s[8:11], s51 offen lds
    v_add_f32_dpp v39, v39, v39 row_shr:4 row_mask:0xf bank_mask:0xf
    v_add_f32_dpp v36, v36, v36 row_shr:8 row_mask:0xf bank_mask:0xf
    v_add_f32_dpp v37, v37, v37 row_shr:8 row_mask:0xf bank_mask:0xf
    v_add_f32_dpp v38, v38, v38 row_shr:8 row_mask:0xf bank_mask:0xf
    v_add_f32_dpp v39, v39, v39 row_shr:8 row_mask:0xf bank_mask:0xf
    v_add_f32_dpp v36, v36, v36 row_bcast:15 row_mask:0xa bank_mask:0xf
    v_add_f32_dpp v37, v37, v37 row_bcast:15 row_mask:0xa bank_mask:0xf
    v_add_f32_dpp v38, v38, v38 row_bcast:15 row_mask:0xa bank_mask:0xf
    v_add_f32_dpp v39, v39, v39 row_bcast:15 row_mask:0xa bank_mask:0xf
    v_add_f32_dpp v36, v36, v36 row_bcast:31 row_mask:0xc bank_mask:0xf
    v_add_f32_dpp v37, v37, v37 row_bcast:31 row_mask:0xc bank_mask:0xf
    v_add_f32_dpp v38, v38, v38 row_bcast:31 row_mask:0xc bank_mask:0xf
    v_add_f32_dpp v39, v39, v39 row_bcast:31 row_mask:0xc bank_mask:0xf
    v_cvt_pk_bf16_f32 v188, v36, v37
    v_cvt_pk_bf16_f32 v190, v38, v39
    v_lshlrev_b32 v36, 16, v188
    v_and_b32 v37, v254, v188
    v_lshlrev_b32 v38, 16, v190
    v_and_b32 v39, v254, v190
    v_mul_f32 v36, 0xbfb8aa3b, v36
    v_mul_f32 v37, 0xbfb8aa3b, v37
    v_mul_f32 v38, 0xbfb8aa3b, v38
    v_mul_f32 v39, 0xbfb8aa3b, v39
    v_exp_f32 v36, v36
    v_exp_f32 v37, v37
    v_exp_f32 v38, v38
    v_exp_f32 v39, v39
    v_add_f32 v36, 1.0, v36
    v_add_f32 v37, 1.0, v37
    v_add_f32 v38, 1.0, v38
    v_add_f32 v39, 1.0, v39
    v_rcp_f32 v36, v36
    v_rcp_f32 v37, v37
    v_rcp_f32 v38, v38
    v_rcp_f32 v39, v39
    v_cvt_pk_bf16_f32 v188, v36, v37
    v_cvt_pk_bf16_f32 v190, v38, v39
    v_lshlrev_b32 v36, 16, v188
    v_and_b32 v37, v254, v188
    v_lshlrev_b32 v38, 16, v190
    v_and_b32 v39, v254, v190
    s_lshl1_add_u32 s13, s47, s44
    s_lshl4_add_u32 s13, s13, s45
    s_lshl_b32 s12, s13, 10
    s_add_u32 s12, s12, 0x950000
    s_lshl_b32 s13, s13, 7
    s_add_u32 s13, s13, 0x9d0000
    v_lshrrev_b32 v240, 5, v1
    v_xor_b32 v240, s43, v240
    v_lshl_add_u32 v0, v240, 30, v34
    v_mov_b32 v246, s28
    v_mov_b32 v247, s29
    v_writelane_b32 v246, s20, 4
    v_writelane_b32 v247, s21, 4
    v_writelane_b32 v246, s16, 8
    v_writelane_b32 v247, s17, 8
    v_writelane_b32 v246, s38, 12
    v_writelane_b32 v247, s39, 12
    global_load_dword v253, v[246:247], off
    v_lshlrev_b32 v246, 21, v1
    v_readlane_b32 s99, v28, 63
    s_nop 3
    v_writelane_b32 v246, s99, 12
    buffer_load_dword v253, v246, s[24:27], 0 offen sc1
    s_waitcnt vmcnt(18)
    s_barrier
    ds_read_b128 a[0:3], v14 offset:0
    ds_read_b128 a[4:7], v18 offset:0
    ds_read_b64_tr_b16 v[40:41], v22 offset:0
    ds_read_b64_tr_b16 v[42:43], v22 offset:1024
    ds_read_b64_tr_b16 v[44:45], v22 offset:512
    ds_read_b64_tr_b16 v[46:47], v22 offset:1536
    ds_read_b128 a[8:11], v15 offset:0
    ds_read_b128 a[12:15], v19 offset:0
    ds_read_b64_tr_b16 v[48:49], v22 offset:4096
    ds_read_b64_tr_b16 v[50:51], v22 offset:5120
    ds_read_b64_tr_b16 v[52:53], v22 offset:4608
    ds_read_b64_tr_b16 v[54:55], v22 offset:5632
    s_waitcnt lgkmcnt(6)
    v_mfma_f32_32x32x16_bf16 v[64:79], a[0:3], v[40:43], 0
    ds_read_b128 a[16:19], v16 offset:0
    ds_read_b128 a[20:23], v20 offset:0
    v_mfma_f32_32x32x16_bf16 v[80:95], a[4:7], v[40:43], 0
    ds_read_b64_tr_b16 v[56:57], v22 offset:8192
    ds_read_b64_tr_b16 v[58:59], v22 offset:9216
    v_mfma_f32_32x32x16_bf16 v[96:111], a[0:3], v[44:47], 0
    ds_read_b64_tr_b16 v[60:61], v22 offset:8704
    ds_read_b64_tr_b16 v[62:63], v22 offset:9728
    v_mfma_f32_32x32x16_bf16 v[112:127], a[4:7], v[44:47], 0
    s_waitcnt lgkmcnt(6)
    v_mfma_f32_32x32x16_bf16 v[64:79], a[8:11], v[48:51], v[64:79]
    ds_read_b128 a[24:27], v17 offset:0
    ds_read_b128 a[28:31], v21 offset:0
    v_mfma_f32_32x32x16_bf16 v[80:95], a[12:15], v[48:51], v[80:95]
    ds_read_b64_tr_b16 v[40:41], v22 offset:12288
    ds_read_b64_tr_b16 v[42:43], v22 offset:13312
    v_mfma_f32_32x32x16_bf16 v[96:111], a[8:11], v[52:55], v[96:111]
    ds_read_b64_tr_b16 v[44:45], v22 offset:12800
    ds_read_b64_tr_b16 v[46:47], v22 offset:13824
    v_mfma_f32_32x32x16_bf16 v[112:127], a[12:15], v[52:55], v[112:127]
    s_waitcnt vmcnt(10)
    s_barrier
    s_waitcnt lgkmcnt(6)
    v_mfma_f32_32x32x16_bf16 v[64:79], a[16:19], v[56:59], v[64:79]
    ds_read_b128 a[32:35], v14 offset:16384
    ds_read_b128 a[36:39], v18 offset:16384
    s_add_u32 s53, s52, 3
    s_and_b32 s53, s53, 7
    s_lshl_b32 s50, s45, 10
    s_add_u32 s50, s50, s53
    s_lshl_b32 s50, s50, 7
    s_mul_i32 s51, s53, 196608
    s_add_u32 m0, s63, 49152
    s_nop 0
    buffer_load_dwordx4 v2, s[4:7], s50 offen lds
    s_add_u32 m0, s63, 114688
    v_mfma_f32_32x32x16_bf16 v[80:95], a[20:23], v[56:59], v[80:95]
    ds_read_b64_tr_b16 v[48:49], v22 offset:16384
    ds_read_b64_tr_b16 v[50:51], v22 offset:17408
    buffer_load_dwordx4 v6, s[8:11], s51 offen lds
    s_add_u32 m0, s63, 53248
    v_lshrrev_b32 v240, 5, v1
    v_and_b32 v241, 31, v1
    v_mfma_f32_32x32x16_bf16 v[96:111], a[16:19], v[60:63], v[96:111]
    ds_read_b64_tr_b16 v[52:53], v22 offset:16896
    ds_read_b64_tr_b16 v[54:55], v22 offset:17920
    buffer_load_dwordx4 v3, s[4:7], s50 offen lds
    s_add_u32 m0, s63, 118784
    v_lshlrev_b32 v240, 2, v240
    v_sub_u32 v240, v241, v240
    v_mfma_f32_32x32x16_bf16 v[112:127], a[20:23], v[60:63], v[112:127]
    v_and_b32 v242, 1, v240
    v_lshlrev_b32 v242, 4, v242
    v_mov_b32 v243, 0x3f80
    s_waitcnt lgkmcnt(6)
    v_mfma_f32_32x32x16_bf16 v[64:79], a[24:27], v[40:43], v[64:79]
    ds_read_b128 a[40:43], v15 offset:16384
    ds_read_b128 a[44:47], v19 offset:16384
    buffer_load_dwordx4 v7, s[8:11], s51 offen lds
    s_add_u32 m0, s63, 57344
    v_lshlrev_b32 v242, v242, v243
    v_ashrrev_i32 v240, 1, v240
    v_mfma_f32_32x32x16_bf16 v[80:95], a[28:31], v[40:43], v[80:95]
    ds_read_b64_tr_b16 v[56:57], v22 offset:20480
    ds_read_b64_tr_b16 v[58:59], v22 offset:21504
    buffer_load_dwordx4 v4, s[4:7], s50 offen lds
    s_add_u32 m0, s63, 122880
    v_cmp_eq_u32 vcc, 0, v240
    v_cmp_eq_u32 s[32:33], 1, v240
    v_mfma_f32_32x32x16_bf16 v[96:111], a[24:27], v[44:47], v[96:111]
    ds_read_b64_tr_b16 v[60:61], v22 offset:20992
    ds_read_b64_tr_b16 v[62:63], v22 offset:22016
    v_cmp_eq_u32 s[34:35], 4, v240
    v_cndmask_b32 v188, 0, v242, vcc
    v_cmp_eq_u32 vcc, 5, v240
    v_mfma_f32_32x32x16_bf16 v[112:127], a[28:31], v[44:47], v[112:127]
    buffer_load_dwordx4 v8, s[8:11], s51 offen lds
    s_add_u32 m0, s63, 61440
    v_cndmask_b32 v189, 0, v242, s[32:33]
    v_cmp_eq_u32 s[32:33], 8, v240
    v_cndmask_b32 v190, 0, v242, s[34:35]
    s_waitcnt lgkmcnt(6)
    v_mfma_f32_32x32x16_bf16 v[64:79], a[32:35], v[48:51], v[64:79]
    ds_read_b128 a[48:51], v16 offset:16384
    ds_read_b128 a[52:55], v20 offset:16384
    buffer_load_dwordx4 v5, s[4:7], s50 offen lds
    s_add_u32 m0, s63, 126976
    v_cmp_eq_u32 s[34:35], 9, v240
    v_cndmask_b32 v191, 0, v242, vcc
    v_mfma_f32_32x32x16_bf16 v[80:95], a[36:39], v[48:51], v[80:95]
    ds_read_b64_tr_b16 v[40:41], v22 offset:24576
    ds_read_b64_tr_b16 v[42:43], v22 offset:25600
    v_cmp_eq_u32 vcc, 12, v240
    v_cndmask_b32 v192, 0, v242, s[32:33]
    v_cmp_eq_u32 s[32:33], 13, v240
    v_mfma_f32_32x32x16_bf16 v[96:111], a[32:35], v[52:55], v[96:111]
    ds_read_b64_tr_b16 v[44:45], v22 offset:25088
    ds_read_b64_tr_b16 v[46:47], v22 offset:26112
    buffer_load_dwordx4 v9, s[8:11], s51 offen lds
    v_cndmask_b32 v193, 0, v242, s[34:35]
    v_cndmask_b32 v194, 0, v242, vcc
    v_cndmask_b32 v195, 0, v242, s[32:33]
    v_mfma_f32_32x32x16_bf16 v[112:127], a[36:39], v[52:55], v[112:127]
    v_mov_b32 v176, 0x3f803f80
    v_mov_b32 v177, 0x3f803f80
    v_mov_b32 v178, 0x3f803f80
    s_waitcnt lgkmcnt(6)
    v_mfma_f32_32x32x16_bf16 v[64:79], a[40:43], v[56:59], v[64:79]
    ds_read_b128 a[56:59], v17 offset:16384
    ds_read_b128 a[60:63], v21 offset:16384
    v_mov_b32 v179, 0x3f803f80
    s_lshl_b32 s99, s42, 8
    s_add_u32 s99, s99, 155648
    v_mfma_f32_32x32x16_bf16 v[80:95], a[44:47], v[56:59], v[80:95]
    ds_read_b64_tr_b16 v[48:49], v22 offset:28672
    ds_read_b64_tr_b16 v[50:51], v22 offset:29696
    v_lshl_add_u32 v182, v1, 2, s99
    v_xor_b32 v183, 0x200, v182
    v_lshlrev_b32 v244, 2, v1
    v_mfma_f32_32x32x16_bf16 v[96:111], a[40:43], v[60:63], v[96:111]
    ds_read_b64_tr_b16 v[52:53], v22 offset:29184
    ds_read_b64_tr_b16 v[54:55], v22 offset:30208
    s_lshl_b32 s99, s42, 11
    s_add_u32 s99, s99, 147456
    v_add_u32 v240, s99, v34
    v_mfma_f32_32x32x16_bf16 v[112:127], a[44:47], v[60:63], v[112:127]
    v_xor_b32 v241, 0x1000, v240
    s_lshl_b32 s99, s42, 8
    s_add_u32 s99, s99, 155648
    s_waitcnt vmcnt(10)
    s_barrier
    s_waitcnt lgkmcnt(6)
    v_mfma_f32_32x32x16_bf16 v[64:79], a[48:51], v[40:43], v[64:79]
    ds_read_b128 a[64:67], v14 offset:32768
    ds_read_b128 a[68:71], v18 offset:32768
    s_add_u32 s53, s52, 4
    s_and_b32 s53, s53, 7
    s_lshl_b32 s50, s45, 10
    s_add_u32 s50, s50, s53
    s_lshl_b32 s50, s50, 7
    s_mul_i32 s51, s53, 196608
    s_add_u32 m0, s63, 0
    s_nop 0
    buffer_load_dwordx4 v2, s[4:7], s50 offen lds
    s_add_u32 m0, s63, 65536
    v_mfma_f32_32x32x16_bf16 v[80:95], a[52:55], v[40:43], v[80:95]
    ds_read_b64_tr_b16 v[56:57], v22 offset:32768
    ds_read_b64_tr_b16 v[58:59], v22 offset:33792
    buffer_load_dwordx4 v6, s[8:11], s51 offen lds
    s_add_u32 m0, s63, 4096
    v_add_u32 v242, s99, v244
    v_and_b32 v243, 16, v1
    v_mfma_f32_32x32x16_bf16 v[96:111], a[48:51], v[44:47], v[96:111]
    ds_read_b64_tr_b16 v[60:61], v22 offset:33280
    ds_read_b64_tr_b16 v[62:63], v22 offset:34304
    buffer_load_dwordx4 v3, s[4:7], s50 offen lds
    s_add_u32 m0, s63, 69632
    v_cmp_eq_u32 vcc, 0, v243
    v_xor_b32 v243, 16, v243
    v_mfma_f32_32x32x16_bf16 v[112:127], a[52:55], v[44:47], v[112:127]
    v_lshrrev_b32 v245, 5, v1
    v_lshl_add_u32 v243, v245, 2, v243
    s_lshl_b32 s99, s44, 8
    s_waitcnt lgkmcnt(6)
    v_mfma_f32_32x32x16_bf16 v[64:79], a[56:59], v[48:51], v[64:79]
    ds_read_b128 a[72:75], v15 offset:32768
    ds_read_b128 a[76:79], v19 offset:32768
    buffer_load_dwordx4 v7, s[8:11], s51 offen lds
    s_add_u32 m0, s63, 8192
    s_add_u32 s99, s99, 155648
    v_lshl_add_u32 v243, v243, 2, s99
    v_mfma_f32_32x32x16_bf16 v[80:95], a[60:63], v[48:51], v[80:95]
    ds_read_b64_tr_b16 v[40:41], v22 offset:36864
    ds_read_b64_tr_b16 v[42:43], v22 offset:37888
    buffer_load_dwordx4 v4, s[4:7], s50 offen lds
    s_add_u32 m0, s63, 73728
    s_lshl_b32 s54, s47, 1
    s_add_u32 s54, s54, s44
    v_mfma_f32_32x32x16_bf16 v[96:111], a[56:59], v[52:55], v[96:111]
    ds_read_b64_tr_b16 v[44:45], v22 offset:37376
    ds_read_b64_tr_b16 v[46:47], v22 offset:38400
    s_lshl_b32 s99, s54, 15
    s_add_u32 s3, s99, 1835008
    s_add_u32 s2, s99, 1851392
    v_mfma_f32_32x32x16_bf16 v[112:127], a[60:63], v[52:55], v[112:127]
    buffer_load_dwordx4 v8, s[8:11], s51 offen lds
    s_add_u32 m0, s63, 12288
    s_lshl_b32 s99, s54, 1
    s_add_u32 s99, s99, s43
    s_lshl_b32 s54, s99, 13
    s_waitcnt lgkmcnt(6)
    v_mfma_f32_32x32x16_bf16 v[64:79], a[64:67], v[56:59], v[64:79]
    ds_read_b128 a[80:83], v16 offset:32768
    ds_read_b128 a[84:87], v20 offset:32768
    buffer_load_dwordx4 v5, s[4:7], s50 offen lds
    s_add_u32 m0, s63, 77824
    v_mfma_f32_32x32x16_bf16 v[80:95], a[68:71], v[56:59], v[80:95]
    ds_read_b64_tr_b16 v[48:49], v22 offset:40960
    ds_read_b64_tr_b16 v[50:51], v22 offset:41984
    s_add_u32 s54, s54, 0x950000
    s_lshl_b32 s99, s99, 10
    s_add_u32 s99, s99, 0x9d0000
    v_mfma_f32_32x32x16_bf16 v[96:111], a[64:67], v[60:63], v[96:111]
    ds_read_b64_tr_b16 v[52:53], v22 offset:41472
    ds_read_b64_tr_b16 v[54:55], v22 offset:42496
    buffer_load_dwordx4 v9, s[8:11], s51 offen lds
    v_mfma_f32_32x32x16_bf16 v[112:127], a[68:71], v[60:63], v[112:127]
    s_lshl_b32 s33, s45, 2
    s_add_u32 s33, s33, s42
    s_lshl_b32 s33, s33, 7
    s_waitcnt lgkmcnt(6)
    v_mfma_f32_32x32x16_bf16 v[64:79], a[72:75], v[40:43], v[64:79]
    ds_read_b128 a[88:91], v17 offset:32768
    ds_read_b128 a[92:95], v21 offset:32768
    s_add_u32 s33, s33, 0x9e0000
    s_xor_b32 s32, s33, 0x80
    s_add_u32 s100, s24, s59
    s_addc_u32 s101, s25, 0
    v_mfma_f32_32x32x16_bf16 v[80:95], a[76:79], v[40:43], v[80:95]
    ds_read_b64_tr_b16 v[56:57], v22 offset:45056
    ds_read_b64_tr_b16 v[58:59], v22 offset:46080
    v_mfma_f32_32x32x16_bf16 v[96:111], a[72:75], v[44:47], v[96:111]
    ds_read_b64_tr_b16 v[60:61], v22 offset:45568
    ds_read_b64_tr_b16 v[62:63], v22 offset:46592
    v_mfma_f32_32x32x16_bf16 v[112:127], a[76:79], v[44:47], v[112:127]
    s_waitcnt vmcnt(8)
    s_barrier
    s_waitcnt lgkmcnt(6)
    v_mfma_f32_32x32x16_bf16 v[64:79], a[80:83], v[48:51], v[64:79]
    ds_read_b128 a[96:99], v14 offset:49152
    ds_read_b128 a[100:103], v18 offset:49152
    s_add_u32 s53, s52, 5
    s_and_b32 s53, s53, 7
    s_lshl_b32 s50, s45, 10
    s_add_u32 s50, s50, s53
    s_lshl_b32 s50, s50, 7
    s_mul_i32 s51, s53, 196608
    s_add_u32 m0, s63, 16384
    s_nop 0
    buffer_load_dwordx4 v2, s[4:7], s50 offen lds
    s_add_u32 m0, s63, 81920
    v_mfma_f32_32x32x16_bf16 v[80:95], a[84:87], v[48:51], v[80:95]
    ds_read_b64_tr_b16 v[40:41], v22 offset:49152
    ds_read_b64_tr_b16 v[42:43], v22 offset:50176
    buffer_load_dwordx4 v6, s[8:11], s51 offen lds
    s_add_u32 m0, s63, 20480
    v_mfma_f32_32x32x16_bf16 v[96:111], a[80:83], v[52:55], v[96:111]
    ds_read_b64_tr_b16 v[44:45], v22 offset:49664
    ds_read_b64_tr_b16 v[46:47], v22 offset:50688
    buffer_load_dwordx4 v3, s[4:7], s50 offen lds
    s_add_u32 m0, s63, 86016
    v_mfma_f32_32x32x16_bf16 v[112:127], a[84:87], v[52:55], v[112:127]
    s_waitcnt lgkmcnt(6)
    v_mfma_f32_32x32x16_bf16 v[64:79], a[88:91], v[56:59], v[64:79]
    ds_read_b128 a[104:107], v15 offset:49152
    ds_read_b128 a[108:111], v19 offset:49152
    buffer_load_dwordx4 v7, s[8:11], s51 offen lds
    s_add_u32 m0, s63, 24576
    v_mfma_f32_32x32x16_bf16 v[80:95], a[92:95], v[56:59], v[80:95]
    ds_read_b64_tr_b16 v[48:49], v22 offset:53248
    ds_read_b64_tr_b16 v[50:51], v22 offset:54272
    buffer_load_dwordx4 v4, s[4:7], s50 offen lds
    s_add_u32 m0, s63, 90112
    v_mfma_f32_32x32x16_bf16 v[96:111], a[88:91], v[60:63], v[96:111]
    ds_read_b64_tr_b16 v[52:53], v22 offset:53760
    ds_read_b64_tr_b16 v[54:55], v22 offset:54784
    v_mfma_f32_32x32x16_bf16 v[112:127], a[92:95], v[60:63], v[112:127]
    buffer_load_dwordx4 v8, s[8:11], s51 offen lds
    s_add_u32 m0, s63, 28672
    s_waitcnt lgkmcnt(6)
    v_mfma_f32_32x32x16_bf16 v[64:79], a[96:99], v[40:43], v[64:79]
    ds_read_b128 a[112:115], v16 offset:49152
    ds_read_b128 a[116:119], v20 offset:49152
    buffer_load_dwordx4 v5, s[4:7], s50 offen lds
    s_add_u32 m0, s63, 94208
    v_mfma_f32_32x32x16_bf16 v[80:95], a[100:103], v[40:43], v[80:95]
    ds_read_b64_tr_b16 v[56:57], v22 offset:57344
    ds_read_b64_tr_b16 v[58:59], v22 offset:58368
    v_mfma_f32_32x32x16_bf16 v[96:111], a[96:99], v[44:47], v[96:111]
    ds_read_b64_tr_b16 v[60:61], v22 offset:57856
    ds_read_b64_tr_b16 v[62:63], v22 offset:58880
    buffer_load_dwordx4 v9, s[8:11], s51 offen lds
    v_mfma_f32_32x32x16_bf16 v[112:127], a[100:103], v[44:47], v[112:127]
    s_waitcnt lgkmcnt(6)
    v_mfma_f32_32x32x16_bf16 v[64:79], a[104:107], v[48:51], v[64:79]
    ds_read_b128 a[120:123], v17 offset:49152
    ds_read_b128 a[124:127], v21 offset:49152
    v_mfma_f32_32x32x16_bf16 v[80:95], a[108:111], v[48:51], v[80:95]
    ds_read_b64_tr_b16 v[40:41], v22 offset:61440
    ds_read_b64_tr_b16 v[42:43], v22 offset:62464
    v_mfma_f32_32x32x16_bf16 v[96:111], a[104:107], v[52:55], v[96:111]
    ds_read_b64_tr_b16 v[44:45], v22 offset:61952
    ds_read_b64_tr_b16 v[46:47], v22 offset:62976
    v_mfma_f32_32x32x16_bf16 v[112:127], a[108:111], v[52:55], v[112:127]
    s_waitcnt vmcnt(8)
    s_barrier
    s_waitcnt lgkmcnt(6)
    v_mfma_f32_32x32x16_bf16 v[64:79], a[112:115], v[56:59], v[64:79]
    ds_read_b128 a[128:131], v14 offset:0
    ds_read_b128 a[132:135], v18 offset:0
    s_add_u32 s53, s52, 6
    s_and_b32 s53, s53, 7
    s_lshl_b32 s50, s45, 10
    s_add_u32 s50, s50, s53
    s_lshl_b32 s50, s50, 7
    s_mul_i32 s51, s53, 196608
    s_add_u32 m0, s63, 32768
    s_nop 0
    buffer_load_dwordx4 v2, s[4:7], s50 offen lds
    s_add_u32 m0, s63, 98304
    v_mfma_f32_32x32x16_bf16 v[80:95], a[116:119], v[56:59], v[80:95]
    ds_read_b64_tr_b16 v[48:49], v22 offset:0
    ds_read_b64_tr_b16 v[50:51], v22 offset:1024
    buffer_load_dwordx4 v6, s[8:11], s51 offen lds
    s_add_u32 m0, s63, 36864
    v_mfma_f32_32x32x16_bf16 v[96:111], a[112:115], v[60:63], v[96:111]
    ds_read_b64_tr_b16 v[52:53], v22 offset:512
    ds_read_b64_tr_b16 v[54:55], v22 offset:1536
    buffer_load_dwordx4 v3, s[4:7], s50 offen lds
    s_add_u32 m0, s63, 102400
    v_mfma_f32_32x32x16_bf16 v[112:127], a[116:119], v[60:63], v[112:127]
    s_waitcnt lgkmcnt(6)
    v_mfma_f32_32x32x16_bf16 v[64:79], a[120:123], v[40:43], v[64:79]
    ds_read_b128 a[136:139], v15 offset:0
    ds_read_b128 a[140:143], v19 offset:0
    buffer_load_dwordx4 v7, s[8:11], s51 offen lds
    s_add_u32 m0, s63, 40960
    v_mfma_f32_32x32x16_bf16 v[80:95], a[124:127], v[40:43], v[80:95]
    ds_read_b64_tr_b16 v[56:57], v22 offset:4096
    ds_read_b64_tr_b16 v[58:59], v22 offset:5120
    buffer_load_dwordx4 v4, s[4:7], s50 offen lds
    s_add_u32 m0, s63, 106496
    v_mfma_f32_32x32x16_bf16 v[96:111], a[120:123], v[44:47], v[96:111]
    ds_read_b64_tr_b16 v[60:61], v22 offset:4608
    ds_read_b64_tr_b16 v[62:63], v22 offset:5632
    v_mfma_f32_32x32x16_bf16 v[112:127], a[124:127], v[44:47], v[112:127]
    buffer_load_dwordx4 v8, s[8:11], s51 offen lds
    s_add_u32 m0, s63, 45056
    s_waitcnt lgkmcnt(6)
    v_mfma_f32_32x32x16_bf16 v[64:79], a[128:131], v[48:51], v[64:79]
    ds_read_b128 a[144:147], v16 offset:0
    ds_read_b128 a[148:151], v20 offset:0
    buffer_load_dwordx4 v5, s[4:7], s50 offen lds
    s_add_u32 m0, s63, 110592
    v_mfma_f32_32x32x16_bf16 v[80:95], a[132:135], v[48:51], v[80:95]
    ds_read_b64_tr_b16 v[40:41], v22 offset:8192
    ds_read_b64_tr_b16 v[42:43], v22 offset:9216
    v_mfma_f32_32x32x16_bf16 v[96:111], a[128:131], v[52:55], v[96:111]
    ds_read_b64_tr_b16 v[44:45], v22 offset:8704
    ds_read_b64_tr_b16 v[46:47], v22 offset:9728
    buffer_load_dwordx4 v9, s[8:11], s51 offen lds
    v_mfma_f32_32x32x16_bf16 v[112:127], a[132:135], v[52:55], v[112:127]
    s_waitcnt lgkmcnt(6)
    v_mfma_f32_32x32x16_bf16 v[64:79], a[136:139], v[56:59], v[64:79]
    ds_read_b128 a[152:155], v17 offset:0
    ds_read_b128 a[156:159], v21 offset:0
    v_mfma_f32_32x32x16_bf16 v[80:95], a[140:143], v[56:59], v[80:95]
    ds_read_b64_tr_b16 v[48:49], v22 offset:12288
    ds_read_b64_tr_b16 v[50:51], v22 offset:13312
    v_mfma_f32_32x32x16_bf16 v[96:111], a[136:139], v[60:63], v[96:111]
    ds_read_b64_tr_b16 v[52:53], v22 offset:12800
    ds_read_b64_tr_b16 v[54:55], v22 offset:13824
    v_mfma_f32_32x32x16_bf16 v[112:127], a[140:143], v[60:63], v[112:127]
    s_waitcnt vmcnt(8)
    s_barrier
    s_waitcnt lgkmcnt(6)
    v_mfma_f32_32x32x16_bf16 v[64:79], a[144:147], v[40:43], v[64:79]
    ds_read_b128 a[160:163], v14 offset:16384
    ds_read_b128 a[164:167], v18 offset:16384
    s_add_u32 s53, s52, 7
    s_and_b32 s53, s53, 7
    s_lshl_b32 s50, s45, 10
    s_add_u32 s50, s50, s53
    s_lshl_b32 s50, s50, 7
    s_mul_i32 s51, s53, 196608
    s_add_u32 m0, s63, 49152
    s_nop 0
    buffer_load_dwordx4 v2, s[4:7], s50 offen lds
    s_add_u32 m0, s63, 114688
    v_mfma_f32_32x32x16_bf16 v[80:95], a[148:151], v[40:43], v[80:95]
    ds_read_b64_tr_b16 v[56:57], v22 offset:16384
    ds_read_b64_tr_b16 v[58:59], v22 offset:17408
    buffer_load_dwordx4 v6, s[8:11], s51 offen lds
    s_add_u32 m0, s63, 53248
    v_mfma_f32_32x32x16_bf16 v[96:111], a[144:147], v[44:47], v[96:111]
    ds_read_b64_tr_b16 v[60:61], v22 offset:16896
    ds_read_b64_tr_b16 v[62:63], v22 offset:17920
    buffer_load_dwordx4 v3, s[4:7], s50 offen lds
    s_add_u32 m0, s63, 118784
    v_mfma_f32_32x32x16_bf16 v[112:127], a[148:151], v[44:47], v[112:127]
    s_waitcnt lgkmcnt(6)
    v_mfma_f32_32x32x16_bf16 v[64:79], a[152:155], v[48:51], v[64:79]
    ds_read_b128 a[168:171], v15 offset:16384
    ds_read_b128 a[172:175], v19 offset:16384
    buffer_load_dwordx4 v7, s[8:11], s51 offen lds
    s_add_u32 m0, s63, 57344
    v_mfma_f32_32x32x16_bf16 v[80:95], a[156:159], v[48:51], v[80:95]
    ds_read_b64_tr_b16 v[40:41], v22 offset:20480
    ds_read_b64_tr_b16 v[42:43], v22 offset:21504
    buffer_load_dwordx4 v4, s[4:7], s50 offen lds
    s_add_u32 m0, s63, 122880
    v_mfma_f32_32x32x16_bf16 v[96:111], a[152:155], v[52:55], v[96:111]
    ds_read_b64_tr_b16 v[44:45], v22 offset:20992
    ds_read_b64_tr_b16 v[46:47], v22 offset:22016
    v_mfma_f32_32x32x16_bf16 v[112:127], a[156:159], v[52:55], v[112:127]
    buffer_load_dwordx4 v8, s[8:11], s51 offen lds
    s_add_u32 m0, s63, 61440
    s_waitcnt lgkmcnt(6)
    v_mfma_f32_32x32x16_bf16 v[64:79], a[160:163], v[56:59], v[64:79]
    ds_read_b128 a[176:179], v16 offset:16384
    ds_read_b128 a[180:183], v20 offset:16384
    buffer_load_dwordx4 v5, s[4:7], s50 offen lds
    s_add_u32 m0, s63, 126976
    v_mfma_f32_32x32x16_bf16 v[80:95], a[164:167], v[56:59], v[80:95]
    ds_read_b64_tr_b16 v[48:49], v22 offset:24576
    ds_read_b64_tr_b16 v[50:51], v22 offset:25600
    v_mfma_f32_32x32x16_bf16 v[96:111], a[160:163], v[60:63], v[96:111]
    ds_read_b64_tr_b16 v[52:53], v22 offset:25088
    ds_read_b64_tr_b16 v[54:55], v22 offset:26112
    buffer_load_dwordx4 v9, s[8:11], s51 offen lds
    v_mfma_f32_32x32x16_bf16 v[112:127], a[164:167], v[60:63], v[112:127]
    s_waitcnt lgkmcnt(6)
    v_mfma_f32_32x32x16_bf16 v[64:79], a[168:171], v[40:43], v[64:79]
    ds_read_b128 a[184:187], v17 offset:16384
    ds_read_b128 a[188:191], v21 offset:16384
    v_mfma_f32_32x32x16_bf16 v[80:95], a[172:175], v[40:43], v[80:95]
    ds_read_b64_tr_b16 v[56:57], v22 offset:28672
    ds_read_b64_tr_b16 v[58:59], v22 offset:29696
    v_mfma_f32_32x32x16_bf16 v[96:111], a[168:171], v[44:47], v[96:111]
    ds_read_b64_tr_b16 v[60:61], v22 offset:29184
    ds_read_b64_tr_b16 v[62:63], v22 offset:30208
    v_mfma_f32_32x32x16_bf16 v[112:127], a[172:175], v[44:47], v[112:127]
    s_waitcnt vmcnt(8)
    s_barrier
    s_mov_b32 s97, 0
    s_load_dword s97, s[40:41], 0x0
    s_waitcnt lgkmcnt(6)
    v_mfma_f32_32x32x16_bf16 v[64:79], a[176:179], v[48:51], v[64:79]
    ds_read_b128 a[192:195], v14 offset:32768
    ds_read_b128 a[196:199], v18 offset:32768
    s_add_u32 s53, s52, 0
    s_and_b32 s53, s53, 7
    s_mul_i32 s51, s53, 196608
    s_lshr_b32 m0, s55, 1
    s_add_u32 m0, m0, 0
    s_nop 0
    buffer_load_dwordx4 v10, s[8:11], s51 offen lds
    s_lshr_b32 m0, s55, 1
    s_add_u32 m0, m0, 1024
    v_mfma_f32_32x32x16_bf16 v[80:95], a[180:183], v[48:51], v[80:95]
    ds_read_b64_tr_b16 v[40:41], v22 offset:32768
    ds_read_b64_tr_b16 v[42:43], v22 offset:33792
    buffer_load_dwordx4 v11, s[8:11], s51 offen lds
    s_add_u32 s53, s52, 1
    s_and_b32 s53, s53, 7
    s_mul_i32 s51, s53, 196608
    s_lshr_b32 m0, s55, 1
    s_add_u32 m0, m0, 8192
    v_mfma_f32_32x32x16_bf16 v[96:111], a[176:179], v[52:55], v[96:111]
    ds_read_b64_tr_b16 v[44:45], v22 offset:33280
    ds_read_b64_tr_b16 v[46:47], v22 offset:34304
    v_mfma_f32_32x32x16_bf16 v[112:127], a[180:183], v[52:55], v[112:127]
    buffer_load_dwordx4 v10, s[8:11], s51 offen lds
    s_lshr_b32 m0, s55, 1
    s_add_u32 m0, m0, 9216
    s_waitcnt lgkmcnt(6)
    v_mfma_f32_32x32x16_bf16 v[64:79], a[184:187], v[56:59], v[64:79]
    ds_read_b128 a[200:203], v15 offset:32768
    ds_read_b128 a[204:207], v19 offset:32768
    v_mfma_f32_32x32x16_bf16 v[80:95], a[188:191], v[56:59], v[80:95]
    ds_read_b64_tr_b16 v[48:49], v22 offset:36864
    ds_read_b64_tr_b16 v[50:51], v22 offset:37888
    buffer_load_dwordx4 v11, s[8:11], s51 offen lds
    s_add_u32 s53, s52, 2
    s_and_b32 s53, s53, 7
    s_mul_i32 s51, s53, 196608
    s_lshr_b32 m0, s55, 1
    s_add_u32 m0, m0, 65536
    v_mfma_f32_32x32x16_bf16 v[96:111], a[184:187], v[60:63], v[96:111]
    ds_read_b64_tr_b16 v[52:53], v22 offset:37376
    ds_read_b64_tr_b16 v[54:55], v22 offset:38400
    v_mfma_f32_32x32x16_bf16 v[112:127], a[188:191], v[60:63], v[112:127]
    s_waitcnt lgkmcnt(6)
    v_mfma_f32_32x32x16_bf16 v[64:79], a[192:195], v[40:43], v[64:79]
    ds_read_b128 a[208:211], v16 offset:32768
    ds_read_b128 a[212:215], v20 offset:32768
    buffer_load_dwordx4 v10, s[8:11], s51 offen lds
    s_lshr_b32 m0, s55, 1
    s_add_u32 m0, m0, 66560
    v_mfma_f32_32x32x16_bf16 v[80:95], a[196:199], v[40:43], v[80:95]
    ds_read_b64_tr_b16 v[56:57], v22 offset:40960
    ds_read_b64_tr_b16 v[58:59], v22 offset:41984
    v_mfma_f32_32x32x16_bf16 v[96:111], a[192:195], v[44:47], v[96:111]
    ds_read_b64_tr_b16 v[60:61], v22 offset:41472
    ds_read_b64_tr_b16 v[62:63], v22 offset:42496
    buffer_load_dwordx4 v11, s[8:11], s51 offen lds
    s_add_u32 s53, s52, 3
    s_and_b32 s53, s53, 7
    s_mul_i32 s51, s53, 196608
    s_lshr_b32 m0, s55, 1
    s_add_u32 m0, m0, 73728
    v_mfma_f32_32x32x16_bf16 v[112:127], a[196:199], v[44:47], v[112:127]
    s_waitcnt lgkmcnt(6)
    v_mfma_f32_32x32x16_bf16 v[64:79], a[200:203], v[48:51], v[64:79]
    ds_read_b128 a[216:219], v17 offset:32768
    ds_read_b128 a[220:223], v21 offset:32768
    v_mfma_f32_32x32x16_bf16 v[80:95], a[204:207], v[48:51], v[80:95]
    ds_read_b64_tr_b16 v[40:41], v22 offset:45056
    ds_read_b64_tr_b16 v[42:43], v22 offset:46080
    buffer_load_dwordx4 v10, s[8:11], s51 offen lds
    s_lshr_b32 m0, s55, 1
    s_add_u32 m0, m0, 74752
    v_mfma_f32_32x32x16_bf16 v[96:111], a[200:203], v[52:55], v[96:111]
    ds_read_b64_tr_b16 v[44:45], v22 offset:45568
    ds_read_b64_tr_b16 v[46:47], v22 offset:46592
    v_mfma_f32_32x32x16_bf16 v[112:127], a[204:207], v[52:55], v[112:127]
    buffer_load_dwordx4 v11, s[8:11], s51 offen lds
    s_waitcnt vmcnt(8)
    s_barrier
    s_cmp_lt_u32 s97, 32
    s_cbranch_scc1 LK_i1
LK_id2:
    s_waitcnt lgkmcnt(6)
    v_mfma_f32_32x32x16_bf16 v[64:79], a[208:211], v[56:59], v[64:79]
    ds_read_b128 a[224:227], v14 offset:49152
    ds_read_b128 a[228:231], v18 offset:49152
    v_mfma_f32_32x32x16_bf16 v[80:95], a[212:215], v[56:59], v[80:95]
    ds_read_b64_tr_b16 v[48:49], v22 offset:49152
    ds_read_b64_tr_b16 v[50:51], v22 offset:50176
    v_mfma_f32_32x32x16_bf16 v[96:111], a[208:211], v[60:63], v[96:111]
    ds_read_b64_tr_b16 v[52:53], v22 offset:49664
    ds_read_b64_tr_b16 v[54:55], v22 offset:50688
    s_add_u32 s53, s52, 4
    s_and_b32 s53, s53, 7
    s_mul_i32 s51, s53, 196608
    s_lshr_b32 m0, s55, 1
    s_add_u32 m0, m0, 16384
    s_nop 0
    buffer_load_dwordx4 v10, s[8:11], s51 offen lds
    s_lshr_b32 m0, s55, 1
    s_add_u32 m0, m0, 17408
    v_mfma_f32_32x32x16_bf16 v[112:127], a[212:215], v[60:63], v[112:127]
    s_waitcnt lgkmcnt(6)
    v_mfma_f32_32x32x16_bf16 v[64:79], a[216:219], v[40:43], v[64:79]
    ds_read_b128 a[232:235], v15 offset:49152
    ds_read_b128 a[236:239], v19 offset:49152
    buffer_load_dwordx4 v11, s[8:11], s51 offen lds
    s_add_u32 s53, s52, 5
    s_and_b32 s53, s53, 7
    s_mul_i32 s51, s53, 196608
    s_lshr_b32 m0, s55, 1
    s_add_u32 m0, m0, 24576
    v_mfma_f32_32x32x16_bf16 v[80:95], a[220:223], v[40:43], v[80:95]
    ds_read_b64_tr_b16 v[56:57], v22 offset:53248
    ds_read_b64_tr_b16 v[58:59], v22 offset:54272
    v_mfma_f32_32x32x16_bf16 v[96:111], a[216:219], v[44:47], v[96:111]
    ds_read_b64_tr_b16 v[60:61], v22 offset:53760
    ds_read_b64_tr_b16 v[62:63], v22 offset:54784
    v_mfma_f32_32x32x16_bf16 v[112:127], a[220:223], v[44:47], v[112:127]
    buffer_load_dwordx4 v10, s[8:11], s51 offen lds
    s_lshr_b32 m0, s55, 1
    s_add_u32 m0, m0, 25600
    s_waitcnt lgkmcnt(6)
    v_mfma_f32_32x32x16_bf16 v[64:79], a[224:227], v[48:51], v[64:79]
    ds_read_b128 a[240:243], v16 offset:49152
    ds_read_b128 a[244:247], v20 offset:49152
    ds_read_b64_tr_b16 v[40:41], v22 offset:57344
    ds_read_b64_tr_b16 v[42:43], v22 offset:58368
    ds_read_b64_tr_b16 v[44:45], v22 offset:57856
    ds_read_b64_tr_b16 v[46:47], v22 offset:58880
    s_waitcnt lgkmcnt(6)
    v_mfma_f32_32x32x16_bf16 v[64:79], a[232:235], v[56:59], v[64:79]
    ds_read_b128 a[248:251], v17 offset:49152
    ds_read_b128 a[252:255], v21 offset:49152
    ds_read_b64_tr_b16 v[196:197], v22 offset:61440
    ds_read_b64_tr_b16 v[198:199], v22 offset:62464
    ds_read_b64_tr_b16 v[200:201], v22 offset:61952
    ds_read_b64_tr_b16 v[202:203], v22 offset:62976
    s_waitcnt lgkmcnt(6)
    v_mfma_f32_32x32x16_bf16 v[64:79], a[240:243], v[40:43], v[64:79]
    buffer_load_dwordx4 v11, s[8:11], s51 offen lds
    s_add_u32 s53, s52, 6
    s_and_b32 s53, s53, 7
    s_mul_i32 s51, s53, 196608
    s_lshr_b32 m0, s55, 1
    s_add_u32 m0, m0, 81920
    s_waitcnt lgkmcnt(0)
    v_mfma_f32_32x32x16_bf16 v[64:79], a[248:251], v[196:199], v[64:79]
    s_barrier
    v_mfma_f32_32x32x16_bf16 v[80:95], a[228:231], v[48:51], v[80:95]
    buffer_load_dwordx4 v10, s[8:11], s51 offen lds
    s_lshr_b32 m0, s55, 1
    s_add_u32 m0, m0, 82944
    v_mfma_f32_32x32x16_bf16 v[80:95], a[236:239], v[56:59], v[80:95]
    v_mfma_f32_32x32x16_bf16 v[80:95], a[244:247], v[40:43], v[80:95]
    buffer_load_dwordx4 v11, s[8:11], s51 offen lds
    s_add_u32 s53, s52, 7
    s_and_b32 s53, s53, 7
    s_mul_i32 s51, s53, 196608
    s_lshr_b32 m0, s55, 1
    s_add_u32 m0, m0, 90112
    v_mfma_f32_32x32x16_bf16 v[80:95], a[252:255], v[196:199], v[80:95]
    v_mul_f32 v160, v252, v64
    v_max_f32 v64, v251, v64
    v_mul_f32 v161, v252, v65
    v_max_f32 v65, v251, v65
    v_exp_f32_e64 v160, v160 clamp
    v_mfma_f32_32x32x16_bf16 v[96:111], a[224:227], v[52:55], v[96:111]
    v_mul_f32 v162, v252, v66
    v_max_f32 v66, v251, v66
    v_exp_f32_e64 v161, v161 clamp
    v_mul_f32 v163, v252, v67
    v_max_f32 v67, v251, v67
    v_mfma_f32_32x32x16_bf16 v[96:111], a[232:235], v[60:63], v[96:111]
    buffer_load_dwordx4 v10, s[8:11], s51 offen lds
    s_lshr_b32 m0, s55, 1
    s_add_u32 m0, m0, 91136
    v_exp_f32_e64 v162, v162 clamp
    v_add_f32 v64, v64, v160
    v_mfma_f32_32x32x16_bf16 v[96:111], a[240:243], v[44:47], v[96:111]
    v_mul_f32 v164, v252, v68
    v_max_f32 v68, v251, v68
    v_exp_f32_e64 v163, v163 clamp
    v_add_f32 v65, v65, v161
    v_mul_f32 v165, v252, v69
    v_mfma_f32_32x32x16_bf16 v[96:111], a[248:251], v[200:203], v[96:111]
    buffer_load_dwordx4 v11, s[8:11], s51 offen lds
    v_max_f32 v69, v251, v69
    v_exp_f32_e64 v164, v164 clamp
    v_add_f32 v66, v66, v162
    v_mul_f32 v166, v252, v70
    v_mfma_f32_32x32x16_bf16 v[112:127], a[228:231], v[52:55], v[112:127]
    v_max_f32 v70, v251, v70
    v_exp_f32_e64 v165, v165 clamp
    v_add_f32 v67, v67, v163
    v_mul_f32 v167, v252, v71
    v_max_f32 v71, v251, v71
    v_mfma_f32_32x32x16_bf16 v[112:127], a[236:239], v[60:63], v[112:127]
    v_exp_f32_e64 v166, v166 clamp
    v_add_f32 v68, v68, v164
    v_mul_f32 v160, v252, v72
    v_max_f32 v72, v251, v72
    v_exp_f32_e64 v167, v167 clamp
    v_mfma_f32_32x32x16_bf16 v[112:127], a[244:247], v[44:47], v[112:127]
    buffer_load_dword v253, v250, s[20:23], 0 offen
    v_add_f32 v69, v69, v165
    v_mul_f32 v161, v252, v73
    v_max_f32 v73, v251, v73
    v_exp_f32_e64 v160, v160 clamp
    v_mfma_f32_32x32x16_bf16 v[112:127], a[252:255], v[200:203], v[112:127]
    v_add_f32 v70, v70, v166
    v_mul_f32 v162, v252, v74
    v_max_f32 v74, v251, v74
    v_exp_f32_e64 v161, v161 clamp
    v_add_f32 v71, v71, v167
    v_mul_f32 v163, v252, v75
    v_max_f32 v75, v251, v75
    v_exp_f32_e64 v162, v162 clamp
    v_add_f32 v72, v72, v160
    v_mul_f32 v164, v252, v76
    v_max_f32 v76, v251, v76
    v_exp_f32_e64 v163, v163 clamp
    v_add_f32 v73, v73, v161
    v_mul_f32 v165, v252, v77
    v_max_f32 v77, v251, v77
    v_exp_f32_e64 v164, v164 clamp
    buffer_load_dword v253, v13, s[16:19], 0 offen
    v_add_f32 v74, v74, v162
    v_mul_f32 v166, v252, v78
    v_max_f32 v78, v251, v78
    v_exp_f32_e64 v165, v165 clamp
    v_add_f32 v75, v75, v163
    v_mul_f32 v167, v252, v79
    v_max_f32 v79, v251, v79
    v_exp_f32_e64 v166, v166 clamp
    v_add_f32 v76, v76, v164
    v_exp_f32_e64 v167, v167 clamp
    v_add_f32 v77, v77, v165
    v_add_f32 v78, v78, v166
    v_add_f32 v79, v79, v167
    v_cvt_pk_bf16_f32 v64, v64, v65
    v_cvt_pk_bf16_f32 v65, v66, v67
    v_cvt_pk_bf16_f32 v66, v68, v69
    v_cvt_pk_bf16_f32 v67, v70, v71
    v_cvt_pk_bf16_f32 v68, v72, v73
    v_cvt_pk_bf16_f32 v69, v74, v75
    v_cvt_pk_bf16_f32 v70, v76, v77
    v_cvt_pk_bf16_f32 v71, v78, v79
    v_cvt_pk_bf16_f32 v96, v96, v97
    v_cvt_pk_bf16_f32 v97, v98, v99
    v_cvt_pk_bf16_f32 v98, v100, v101
    v_cvt_pk_bf16_f32 v99, v102, v103
    v_cvt_pk_bf16_f32 v100, v104, v105
    v_cvt_pk_bf16_f32 v101, v106, v107
    v_cvt_pk_bf16_f32 v102, v108, v109
    v_cvt_pk_bf16_f32 v103, v110, v111
    v_pk_mul_f32 v[160:161], v[80:81], v[252:253] op_sel_hi:[1,0]
    v_pk_mul_f32 v[162:163], v[82:83], v[252:253] op_sel_hi:[1,0]
    v_pk_mul_f32 v[164:165], v[84:85], v[252:253] op_sel_hi:[1,0]
    v_pk_mul_f32 v[166:167], v[86:87], v[252:253] op_sel_hi:[1,0]
    v_pk_mul_f32 v[168:169], v[88:89], v[252:253] op_sel_hi:[1,0]
    v_pk_mul_f32 v[170:171], v[90:91], v[252:253] op_sel_hi:[1,0]
    v_pk_mul_f32 v[172:173], v[92:93], v[252:253] op_sel_hi:[1,0]
    v_pk_mul_f32 v[174:175], v[94:95], v[252:253] op_sel_hi:[1,0]
    v_mfma_f32_32x32x16_bf16 v[224:239], v[176:179], v[64:67], 0
    v_exp_f32_e64 v160, v160 clamp
    v_max_f32 v80, v251, v80
    v_exp_f32_e64 v161, v161 clamp
    v_max_f32 v81, v251, v81
    v_exp_f32_e64 v162, v162 clamp
    v_max_f32 v82, v251, v82
    v_mfma_f32_32x32x16_bf16 v[208:223], v[64:67], v[96:99], 0
    v_exp_f32_e64 v163, v163 clamp
    v_max_f32 v83, v251, v83
    v_exp_f32_e64 v164, v164 clamp
    v_max_f32 v84, v251, v84
    v_exp_f32_e64 v165, v165 clamp
    v_max_f32 v85, v251, v85
    v_mfma_f32_32x32x16_bf16 v[224:239], v[176:179], v[68:71], v[224:239]
    v_exp_f32_e64 v166, v166 clamp
    v_max_f32 v86, v251, v86
    v_exp_f32_e64 v167, v167 clamp
    v_max_f32 v87, v251, v87
    v_exp_f32_e64 v168, v168 clamp
    v_max_f32 v88, v251, v88
    v_mfma_f32_32x32x16_bf16 v[208:223], v[68:71], v[100:103], v[208:223]
    v_exp_f32_e64 v169, v169 clamp
    v_max_f32 v89, v251, v89
    v_exp_f32_e64 v170, v170 clamp
    v_max_f32 v90, v251, v90
    v_exp_f32_e64 v171, v171 clamp
    v_max_f32 v91, v251, v91
    v_exp_f32_e64 v172, v172 clamp
    v_max_f32 v92, v251, v92
    v_exp_f32_e64 v173, v173 clamp
    v_max_f32 v93, v251, v93
    v_exp_f32_e64 v174, v174 clamp
    v_max_f32 v94, v251, v94
    v_exp_f32_e64 v175, v175 clamp
    v_max_f32 v95, v251, v95
    v_pk_add_f32 v[80:81], v[80:81], v[160:161]
    v_pk_add_f32 v[82:83], v[82:83], v[162:163]
    v_pk_add_f32 v[84:85], v[84:85], v[164:165]
    v_pk_add_f32 v[86:87], v[86:87], v[166:167]
    v_pk_add_f32 v[88:89], v[88:89], v[168:169]
    v_pk_add_f32 v[90:91], v[90:91], v[170:171]
    v_pk_add_f32 v[92:93], v[92:93], v[172:173]
    v_pk_add_f32 v[94:95], v[94:95], v[174:175]
    v_cvt_pk_bf16_f32 v80, v80, v81
    v_cvt_pk_bf16_f32 v81, v82, v83
    v_cvt_pk_bf16_f32 v82, v84, v85
    v_cvt_pk_bf16_f32 v83, v86, v87
    v_cvt_pk_bf16_f32 v84, v88, v89
    v_cvt_pk_bf16_f32 v85, v90, v91
    v_cvt_pk_bf16_f32 v86, v92, v93
    v_cvt_pk_bf16_f32 v87, v94, v95
    s_waitcnt vmcnt(14)
    s_barrier
    ds_read_b64_tr_b16 v[56:57], v23 offset:0
    ds_read_b64_tr_b16 v[58:59], v23 offset:256
    ds_read_b64_tr_b16 v[60:61], v23 offset:2048
    ds_read_b64_tr_b16 v[62:63], v23 offset:2304
    ds_read_b64_tr_b16 v[40:41], v23 offset:4096
    ds_read_b64_tr_b16 v[42:43], v23 offset:4352
    ds_read_b64_tr_b16 v[44:45], v23 offset:6144
    ds_read_b64_tr_b16 v[46:47], v23 offset:6400
    v_mfma_f32_32x32x16_bf16 v[224:239], v[176:179], v[80:83], v[224:239]
    v_mfma_f32_32x32x16_bf16 v[224:239], v[176:179], v[84:87], v[224:239]
    v_cvt_pk_bf16_f32 v112, v112, v113
    v_cvt_pk_bf16_f32 v113, v114, v115
    v_cvt_pk_bf16_f32 v114, v116, v117
    v_cvt_pk_bf16_f32 v115, v118, v119
    v_cvt_pk_bf16_f32 v116, v120, v121
    v_cvt_pk_bf16_f32 v117, v122, v123
    v_cvt_pk_bf16_f32 v118, v124, v125
    v_cvt_pk_bf16_f32 v119, v126, v127
    v_mfma_f32_32x32x16_bf16 v[208:223], v[80:83], v[112:115], v[208:223]
    s_nop 0
    v_mfma_f32_32x32x16_bf16 v[208:223], v[84:87], v[116:119], v[208:223]
    s_waitcnt lgkmcnt(6)
    v_mfma_f32_32x32x16_bf16 v[128:143], v[56:59], a[0:3], 0
    ds_read_b64_tr_b16 v[48:49], v23 offset:8192
    ds_write_b32 v182, v224
    v_mfma_f32_32x32x16_bf16 v[144:159], v[56:59], a[4:7], 0
    ds_read_b64_tr_b16 v[50:51], v23 offset:8448
    s_waitcnt lgkmcnt(7)
    v_mfma_f32_32x32x16_bf16 v[128:143], v[60:63], a[8:11], v[128:143]
    ds_read_b64_tr_b16 v[52:53], v23 offset:10240
    v_mfma_f32_32x32x16_bf16 v[144:159], v[60:63], a[12:15], v[144:159]
    ds_read_b64_tr_b16 v[54:55], v23 offset:10496
    s_nop 0
    v_cndmask_b32 v208, v216, v208, vcc
    v_cndmask_b32 v209, v217, v209, vcc
    v_cndmask_b32 v210, v218, v210, vcc
    v_cndmask_b32 v211, v219, v211, vcc
    v_cndmask_b32 v212, v220, v212, vcc
    v_cndmask_b32 v213, v221, v213, vcc
    s_waitcnt lgkmcnt(7)
    v_mfma_f32_32x32x16_bf16 v[128:143], v[40:43], a[16:19], v[128:143]
    ds_read_b64_tr_b16 v[56:57], v23 offset:12288
    v_cndmask_b32 v214, v222, v214, vcc
    v_cndmask_b32 v215, v223, v215, vcc
    ds_write_b128 v240, v[208:211]
    ds_write_b128 v240, v[212:215] offset:1024
    v_mfma_f32_32x32x16_bf16 v[144:159], v[40:43], a[20:23], v[144:159]
    ds_read_b64_tr_b16 v[58:59], v23 offset:12544
    s_waitcnt lgkmcnt(9)
    v_mfma_f32_32x32x16_bf16 v[128:143], v[44:47], a[24:27], v[128:143]
    ds_read_b64_tr_b16 v[60:61], v23 offset:14336
    s_waitcnt lgkmcnt(2)
    s_barrier
    ds_read_b128 v[216:219], v241
    ds_read_b128 v[220:223], v241 offset:1024
    ds_read_b32 v225, v183
    v_mfma_f32_32x32x16_bf16 v[144:159], v[44:47], a[28:31], v[144:159]
    ds_read_b64_tr_b16 v[62:63], v23 offset:14592
    s_waitcnt vmcnt(10)
    s_barrier
    v_mfma_f32_32x32x16_bf16 v[128:143], v[48:51], a[32:35], v[128:143]
    ds_read_b64_tr_b16 v[40:41], v24 offset:0
    v_mfma_f32_32x32x16_bf16 v[144:159], v[48:51], a[36:39], v[144:159]
    ds_read_b64_tr_b16 v[42:43], v24 offset:256
    s_waitcnt lgkmcnt(3)
    v_add_f32 v208, v208, v216
    v_add_f32 v209, v209, v217
    v_add_f32 v210, v210, v218
    v_add_f32 v211, v211, v219
    v_add_f32 v212, v212, v220
    v_add_f32 v213, v213, v221
    v_add_f32 v214, v214, v222
    v_add_f32 v215, v215, v223
    v_add_f32 v224, v224, v225
    v_cvt_pk_bf16_f32 v208, v208, v209
    v_cvt_pk_bf16_f32 v209, v210, v211
    v_cvt_pk_bf16_f32 v210, v212, v213
    v_cvt_pk_bf16_f32 v211, v214, v215
    buffer_store_dword v224, v35, s[24:27], s13 offen sc1
    buffer_store_dwordx4 v[208:211], v0, s[24:27], s12 offen sc1
    buffer_store_dwordx4 v[36:39], v28, s[24:27], 0 offen sc1
    s_mov_b32 s60, 0
    s_branch LK_po24
LK_ph4:
    s_waitcnt vmcnt(6)
    s_atomic_add s0, s[100:101], 0x0
    s_atomic_add s0, s[24:25], s15
    s_brev_b32 s60, 1
    s_branch LK_ps3
LK_ph6:
    s_waitcnt vmcnt(7)
    s_atomic_add s0, s[100:101], 0x0
    s_atomic_add s0, s[24:25], s15
    s_brev_b32 s60, 1
    s_branch LK_ps5
LK_ph8:
    s_waitcnt vmcnt(9)
    s_atomic_add s0, s[100:101], 0x0
    s_atomic_add s0, s[24:25], s15
    s_brev_b32 s60, 1
    s_branch LK_ps7
LK_ph10:
    s_waitcnt vmcnt(11)
    s_atomic_add s0, s[100:101], 0x0
    s_atomic_add s0, s[24:25], s15
    s_brev_b32 s60, 1
    s_branch LK_ps9
LK_ph15:
    s_waitcnt vmcnt(13)
    s_atomic_add s0, s[100:101], 0x0
    s_atomic_add s0, s[24:25], s15
    s_brev_b32 s60, 1
    s_branch LK_ps14
LK_ph17:
    s_waitcnt vmcnt(15)
    s_atomic_add s0, s[100:101], 0x0
    s_atomic_add s0, s[24:25], s15
    s_brev_b32 s60, 1
    s_branch LK_ps16
LK_ph19:
    s_waitcnt vmcnt(20)
    s_atomic_add s0, s[100:101], 0x0
    s_atomic_add s0, s[24:25], s15
    s_brev_b32 s60, 1
    s_branch LK_ps18
LK_ph21:
    s_waitcnt vmcnt(23)
    s_atomic_add s0, s[100:101], 0x0
    s_atomic_add s0, s[24:25], s15
    s_brev_b32 s60, 1
    s_branch LK_ps20
LK_ph23:
    s_waitcnt vmcnt(23)
    s_atomic_add s0, s[100:101], 0x0
    s_atomic_add s0, s[24:25], s15
    s_branch LK_pf22
LK_po24:
    v_mfma_f32_32x32x16_bf16 v[128:143], v[52:55], a[40:43], v[128:143]
    ds_read_b64_tr_b16 v[44:45], v24 offset:2048
    s_add_u32 s50, s56, 0
    s_add_u32 m0, s63, 131072
    s_nop 0
    buffer_load_dwordx4 v27, s[20:23], s50 offen lds
    s_add_u32 s50, s56, 16384
    s_add_u32 m0, s63, 135168
    v_mfma_f32_32x32x16_bf16 v[144:159], v[52:55], a[44:47], v[144:159]
    ds_read_b64_tr_b16 v[46:47], v24 offset:2304
    buffer_load_dwordx4 v27, s[20:23], s50 offen lds
    s_add_u32 s50, s56, 32768
    s_add_u32 m0, s63, 139264
    s_add_u32 s37, s48, 1
    s_and_b32 s37, s37, 3
    s_mul_i32 s37, s37, 24576
    s_add_u32 s37, s37, s62
    s_add_u32 s4, s37, 0
    v_mfma_f32_32x32x16_bf16 v[128:143], v[56:59], a[48:51], v[128:143]
    ds_read_b64_tr_b16 v[48:49], v24 offset:4096
    buffer_load_dwordx4 v27, s[20:23], s50 offen lds
    s_add_u32 s50, s56, 49152
    s_add_u32 m0, s63, 143360
    s_add_u32 s37, s48, 2
    s_and_b32 s37, s37, 3
    s_mul_i32 s37, s37, 24576
    s_add_u32 s37, s37, s62
    s_add_u32 s5, s37, 2048
    v_mfma_f32_32x32x16_bf16 v[144:159], v[56:59], a[52:55], v[144:159]
    ds_read_b64_tr_b16 v[50:51], v24 offset:4352
    buffer_load_dwordx4 v27, s[20:23], s50 offen lds
    s_add_u32 s50, s56, 65536
    s_add_u32 m0, s63, 32768
    s_add_u32 s37, s48, 3
    s_and_b32 s37, s37, 3
    s_mul_i32 s37, s37, 24576
    s_add_u32 s37, s37, s62
    s_add_u32 s6, s37, 4096
    s_waitcnt lgkmcnt(6)
    v_mfma_f32_32x32x16_bf16 v[128:143], v[60:63], a[56:59], v[128:143]
    ds_read_b64_tr_b16 v[52:53], v24 offset:6144
    buffer_load_dwordx4 v27, s[20:23], s50 offen lds
    s_add_u32 s50, s56, 81920
    s_add_u32 m0, s63, 36864
    v_and_b32 v15, 31, v1
    s_mul_i32 s41, s42, 2560
    v_mfma_f32_32x32x16_bf16 v[144:159], v[60:63], a[60:63], v[144:159]
    ds_read_b64_tr_b16 v[54:55], v24 offset:6400
    buffer_load_dwordx4 v27, s[20:23], s50 offen lds
    s_add_u32 s50, s56, 98304
    s_add_u32 m0, s63, 40960
    s_add_u32 s41, s41, 147456
    v_mul_u32_u24 v14, 80, v15
    s_waitcnt lgkmcnt(6)
    v_mfma_f32_32x32x16_bf16 v[128:143], v[40:43], a[64:67], v[128:143]
    ds_read_b64_tr_b16 v[56:57], v24 offset:8192
    v_lshrrev_b32 v16, 5, v1
    v_lshl_add_u32 v14, v16, 3, v14
    v_add_u32 v18, s41, v14
    v_lshrrev_b32 v14, 2, v1
    v_and_b32 v16, 3, v1
    v_mfma_f32_32x32x16_bf16 v[144:159], v[40:43], a[68:71], v[144:159]
    ds_read_b64_tr_b16 v[58:59], v24 offset:8448
    v_lshlrev_b32 v16, 4, v16
    v_mul_u32_u24 v17, 80, v14
    v_add3_u32 v19, v17, v16, s41
    v_lshl_add_u32 v20, v14, 10, v16
    s_lshl_b32 s40, s45, 2
    s_waitcnt lgkmcnt(6)
    v_mfma_f32_32x32x16_bf16 v[128:143], v[44:47], a[72:75], v[128:143]
    ds_read_b64_tr_b16 v[60:61], v24 offset:10240
    s_add_u32 s40, s40, s42
    s_lshl_b32 s40, s40, 15
    s_lshl_b32 s41, s49, 2
    s_add_u32 s41, s41, s48
    s_lshl_b32 s41, s41, 6
    v_mfma_f32_32x32x16_bf16 v[144:159], v[44:47], a[76:79], v[144:159]
    ds_read_b64_tr_b16 v[62:63], v24 offset:10496
    s_add_u32 s40, s40, s41
    s_add_u32 s41, s40, 0x4000
    s_waitcnt lgkmcnt(6)
    v_mfma_f32_32x32x16_bf16 v[128:143], v[48:51], a[80:83], v[128:143]
    ds_read_b64_tr_b16 v[40:41], v24 offset:12288
    v_mfma_f32_32x32x16_bf16 v[144:159], v[48:51], a[84:87], v[144:159]
    ds_read_b64_tr_b16 v[42:43], v24 offset:12544
    s_waitcnt lgkmcnt(6)
    v_mfma_f32_32x32x16_bf16 v[128:143], v[52:55], a[88:91], v[128:143]
    ds_read_b64_tr_b16 v[44:45], v24 offset:14336
    v_mfma_f32_32x32x16_bf16 v[144:159], v[52:55], a[92:95], v[144:159]
    ds_read_b64_tr_b16 v[46:47], v24 offset:14592
    s_waitcnt vmcnt(15)
    s_barrier
    s_waitcnt lgkmcnt(6)
    v_mfma_f32_32x32x16_bf16 v[128:143], v[56:59], a[96:99], v[128:143]
    ds_read_b64_tr_b16 v[48:49], v23 offset:16384
    v_mfma_f32_32x32x16_bf16 v[144:159], v[56:59], a[100:103], v[144:159]
    ds_read_b64_tr_b16 v[50:51], v23 offset:16640
    s_waitcnt lgkmcnt(6)
    v_mfma_f32_32x32x16_bf16 v[128:143], v[60:63], a[104:107], v[128:143]
    ds_read_b64_tr_b16 v[52:53], v23 offset:18432
    v_mfma_f32_32x32x16_bf16 v[144:159], v[60:63], a[108:111], v[144:159]
    ds_read_b64_tr_b16 v[54:55], v23 offset:18688
    s_getreg_b32 s37, hwreg(HW_REG_IB_STS)
    s_and_b32 s37, s37, 0xc0000f
    s_or_b32 s37, s37, s60
    s_cmp_le_u32 s37, 0x6
    s_cbranch_scc1 LK_ph4
LK_ps3:
    s_waitcnt lgkmcnt(6)
    v_mfma_f32_32x32x16_bf16 v[128:143], v[40:43], a[112:115], v[128:143]
    ds_read_b64_tr_b16 v[56:57], v23 offset:20480
    v_mfma_f32_32x32x16_bf16 v[144:159], v[40:43], a[116:119], v[144:159]
    ds_read_b64_tr_b16 v[58:59], v23 offset:20736
    s_waitcnt lgkmcnt(6)
    v_mfma_f32_32x32x16_bf16 v[128:143], v[44:47], a[120:123], v[128:143]
    ds_read_b64_tr_b16 v[60:61], v23 offset:22528
    v_mfma_f32_32x32x16_bf16 v[144:159], v[44:47], a[124:127], v[144:159]
    ds_read_b64_tr_b16 v[62:63], v23 offset:22784
    global_load_dword v253, v[248:249], off
    s_mov_b32 s96, 0
    s_atomic_umax s96, s[24:25], s58 glc
    s_waitcnt lgkmcnt(6)
    v_mfma_f32_32x32x16_bf16 v[128:143], v[48:51], a[128:131], v[128:143]
    ds_read_b64_tr_b16 v[40:41], v23 offset:24576
    s_getreg_b32 s37, hwreg(HW_REG_IB_STS)
    s_and_b32 s37, s37, 0xc0000f
    s_or_b32 s37, s37, s60
    s_cmp_le_u32 s37, 0x7
    s_cbranch_scc1 LK_ph6
LK_ps5:
    v_mfma_f32_32x32x16_bf16 v[144:159], v[48:51], a[132:135], v[144:159]
    ds_read_b64_tr_b16 v[42:43], v23 offset:24832
    s_waitcnt lgkmcnt(6)
    v_mfma_f32_32x32x16_bf16 v[128:143], v[52:55], a[136:139], v[128:143]
    ds_read_b64_tr_b16 v[44:45], v23 offset:26624
    v_mfma_f32_32x32x16_bf16 v[144:159], v[52:55], a[140:143], v[144:159]
    ds_read_b64_tr_b16 v[46:47], v23 offset:26880
    buffer_load_dwordx4 v27, s[20:23], s50 offen lds
    s_add_u32 s50, s56, 114688
    s_add_u32 m0, s63, 45056
    s_waitcnt lgkmcnt(6)
    v_mfma_f32_32x32x16_bf16 v[128:143], v[56:59], a[144:147], v[128:143]
    ds_read_b64_tr_b16 v[48:49], v23 offset:28672
    v_mfma_f32_32x32x16_bf16 v[144:159], v[56:59], a[148:151], v[144:159]
    ds_read_b64_tr_b16 v[50:51], v23 offset:28928
    buffer_load_dwordx4 v27, s[20:23], s50 offen lds
    s_add_u32 s50, s56, 327680
    s_add_u32 m0, s63, 98304
    s_waitcnt lgkmcnt(6)
    v_mfma_f32_32x32x16_bf16 v[128:143], v[60:63], a[152:155], v[128:143]
    ds_read_b64_tr_b16 v[52:53], v23 offset:30720
    s_getreg_b32 s37, hwreg(HW_REG_IB_STS)
    s_and_b32 s37, s37, 0xc0000f
    s_or_b32 s37, s37, s60
    s_cmp_le_u32 s37, 0x9
    s_cbranch_scc1 LK_ph8
LK_ps7:
    v_mfma_f32_32x32x16_bf16 v[144:159], v[60:63], a[156:159], v[144:159]
    ds_read_b64_tr_b16 v[54:55], v23 offset:30976
    buffer_load_dwordx4 v27, s[20:23], s50 offen lds
    s_add_u32 s50, s56, 344064
    s_add_u32 m0, s63, 102400
    s_waitcnt vmcnt(15)
    s_barrier
    s_waitcnt lgkmcnt(6)
    v_mfma_f32_32x32x16_bf16 v[128:143], v[40:43], a[160:163], v[128:143]
    ds_read_b64_tr_b16 v[56:57], v24 offset:16384
    v_mfma_f32_32x32x16_bf16 v[144:159], v[40:43], a[164:167], v[144:159]
    ds_read_b64_tr_b16 v[58:59], v24 offset:16640
    buffer_load_dwordx4 v27, s[20:23], s50 offen lds
    s_add_u32 s50, s56, 360448
    s_add_u32 m0, s63, 106496
    s_waitcnt lgkmcnt(6)
    v_mfma_f32_32x32x16_bf16 v[128:143], v[44:47], a[168:171], v[128:143]
    ds_read_b64_tr_b16 v[60:61], v24 offset:18432
    v_mfma_f32_32x32x16_bf16 v[144:159], v[44:47], a[172:175], v[144:159]
    ds_read_b64_tr_b16 v[62:63], v24 offset:18688
    s_getreg_b32 s37, hwreg(HW_REG_IB_STS)
    s_and_b32 s37, s37, 0xc0000f
    s_or_b32 s37, s37, s60
    s_cmp_le_u32 s37, 0xb
    s_cbranch_scc1 LK_ph10
LK_ps9:
    s_waitcnt lgkmcnt(6)
    v_mfma_f32_32x32x16_bf16 v[128:143], v[48:51], a[176:179], v[128:143]
    ds_read_b64_tr_b16 v[40:41], v24 offset:20480
    buffer_load_dwordx4 v27, s[20:23], s50 offen lds
    s_add_u32 s50, s56, 376832
    s_add_u32 m0, s63, 110592
    v_mfma_f32_32x32x16_bf16 v[144:159], v[48:51], a[180:183], v[144:159]
    ds_read_b64_tr_b16 v[42:43], v24 offset:20736
    s_waitcnt lgkmcnt(6)
    v_mfma_f32_32x32x16_bf16 v[128:143], v[52:55], a[184:187], v[128:143]
    ds_read_b64_tr_b16 v[44:45], v24 offset:22528
    buffer_load_dwordx4 v27, s[20:23], s50 offen lds
    s_add_u32 s50, s56, 393216
    s_add_u32 m0, s63, 49152
    v_mfma_f32_32x32x16_bf16 v[144:159], v[52:55], a[188:191], v[144:159]
    ds_read_b64_tr_b16 v[46:47], v24 offset:22784
    s_bfe_u32 s37, s96, 0x80000
    s_cmp_ge_u32 s37, 4
    s_cbranch_scc1 LK_gd12
LK_g11:
    s_waitcnt lgkmcnt(0)
    s_bfe_u32 s37, s96, 0x80000
    s_cmp_ge_u32 s37, 4
    s_cbranch_scc1 LK_gd12
LK_ga13:
    s_cmp_eq_u32 s98, 0
    s_cbranch_scc1 LK_gd12
    s_sub_u32 s98, s98, 1
    s_getreg_b32 s37, hwreg(HW_REG_IB_STS)
    s_and_b32 s37, s37, 0xc0000f
    s_or_b32 s37, s37, s60
    s_cmp_le_u32 s37, 0xd
    s_cbranch_scc1 LK_ph15
LK_ps14:
    s_atomic_umax s96, s[24:25], s58 glc
    s_branch LK_g11
LK_gd12:
    s_waitcnt lgkmcnt(6)
    v_mfma_f32_32x32x16_bf16 v[128:143], v[56:59], a[192:195], v[128:143]
    ds_read_b64_tr_b16 v[48:49], v24 offset:24576
    buffer_load_dwordx4 v27, s[20:23], s50 offen lds
    s_add_u32 s53, s56, 0
    v_mfma_f32_32x32x16_bf16 v[144:159], v[56:59], a[196:199], v[144:159]
    ds_read_b64_tr_b16 v[50:51], v24 offset:24832
    buffer_load_dwordx4 a[0:3], v32, s[24:27], s53 offen sc1
    s_add_u32 s53, s56, 16384
    s_getreg_b32 s37, hwreg(HW_REG_IB_STS)
    s_and_b32 s37, s37, 0xc0000f
    s_or_b32 s37, s37, s60
    s_cmp_le_u32 s37, 0xf
    s_cbranch_scc1 LK_ph17
LK_ps16:
    s_waitcnt lgkmcnt(6)
    v_mfma_f32_32x32x16_bf16 v[128:143], v[60:63], a[200:203], v[128:143]
    ds_read_b64_tr_b16 v[52:53], v24 offset:26624
    buffer_load_dwordx4 a[4:7], v32, s[24:27], s53 offen sc1
    s_add_u32 s53, s56, 32768
    v_mfma_f32_32x32x16_bf16 v[144:159], v[60:63], a[204:207], v[144:159]
    ds_read_b64_tr_b16 v[54:55], v24 offset:26880
    buffer_load_dwordx4 a[8:11], v32, s[24:27], s53 offen sc1
    s_add_u32 s53, s56, 49152
    s_waitcnt lgkmcnt(6)
    v_mfma_f32_32x32x16_bf16 v[128:143], v[40:43], a[208:211], v[128:143]
    ds_read_b64_tr_b16 v[56:57], v24 offset:28672
    buffer_load_dwordx4 a[12:15], v32, s[24:27], s53 offen sc1
    s_add_u32 s53, s56, 65536
    v_mfma_f32_32x32x16_bf16 v[144:159], v[40:43], a[212:215], v[144:159]
    ds_read_b64_tr_b16 v[58:59], v24 offset:28928
    buffer_load_dwordx4 a[16:19], v32, s[24:27], s53 offen sc1
    s_add_u32 s53, s56, 81920
    s_waitcnt lgkmcnt(6)
    v_mfma_f32_32x32x16_bf16 v[128:143], v[44:47], a[216:219], v[128:143]
    ds_read_b64_tr_b16 v[60:61], v24 offset:30720
    buffer_load_dwordx4 a[20:23], v32, s[24:27], s53 offen sc1
    s_add_u32 s53, s56, 98304
    s_getreg_b32 s37, hwreg(HW_REG_IB_STS)
    s_and_b32 s37, s37, 0xc0000f
    s_or_b32 s37, s37, s60
    s_cmp_le_u32 s37, 0x400004
    s_cbranch_scc1 LK_ph19
LK_ps18:
    v_mfma_f32_32x32x16_bf16 v[144:159], v[44:47], a[220:223], v[144:159]
    ds_read_b64_tr_b16 v[62:63], v24 offset:30976
    buffer_load_dwordx4 a[24:27], v32, s[24:27], s53 offen sc1
    s_add_u32 s53, s56, 114688
    s_barrier
    s_waitcnt lgkmcnt(6)
    v_mfma_f32_32x32x16_bf16 v[128:143], v[48:51], a[224:227], v[128:143]
    buffer_load_dwordx4 a[28:31], v32, s[24:27], s53 offen sc1
    s_add_u32 s53, s56, 327680
    v_mfma_f32_32x32x16_bf16 v[144:159], v[48:51], a[228:231], v[144:159]
    buffer_load_dwordx4 a[32:35], v32, s[24:27], s53 offen sc1
    s_add_u32 s53, s56, 344064
    s_getreg_b32 s37, hwreg(HW_REG_IB_STS)
    s_and_b32 s37, s37, 0xc0000f
    s_or_b32 s37, s37, s60
    s_cmp_le_u32 s37, 0x400007
    s_cbranch_scc1 LK_ph21
LK_ps20:
    s_waitcnt lgkmcnt(0)
    s_cmp_eq_u32 s60, 0
    s_cbranch_scc1 LK_ph23
LK_pf22:
    s_mov_b32 s97, 0
    s_atomic_umax s97, s[24:25], s59 glc
    s_mov_b32 s36, 0
    s_atomic_umax s36, s[24:25], s15 glc
    v_mfma_f32_32x32x16_bf16 v[128:143], v[52:55], a[232:235], v[128:143]
    buffer_load_dwordx4 a[36:39], v32, s[24:27], s53 offen sc1
    s_add_u32 s53, s56, 360448
    v_mfma_f32_32x32x16_bf16 v[144:159], v[52:55], a[236:239], v[144:159]
    buffer_load_dwordx4 a[40:43], v32, s[24:27], s53 offen sc1
    s_add_u32 s53, s56, 376832
    v_mfma_f32_32x32x16_bf16 v[128:143], v[56:59], a[240:243], v[128:143]
    buffer_load_dwordx4 a[44:47], v32, s[24:27], s53 offen sc1
    s_add_u32 s53, s56, 393216
    v_mfma_f32_32x32x16_bf16 v[144:159], v[56:59], a[244:247], v[144:159]
    buffer_load_dwordx4 a[48:51], v32, s[24:27], s53 offen sc1
    s_add_u32 s53, s56, 409600
    v_mfma_f32_32x32x16_bf16 v[128:143], v[60:63], a[248:251], v[128:143]
    buffer_load_dwordx4 a[52:55], v32, s[24:27], s53 offen sc1
    s_add_u32 s53, s56, 425984
    v_mfma_f32_32x32x16_bf16 v[144:159], v[60:63], a[252:255], v[144:159]
    buffer_load_dwordx4 a[56:59], v32, s[24:27], s53 offen sc1
    s_add_u32 s53, s56, 442368
    s_waitcnt vmcnt(16)
    s_barrier
    buffer_load_dwordx4 a[60:63], v32, s[24:27], s53 offen sc1
    s_add_u32 s50, s56, 409600
    s_add_u32 m0, s63, 53248
    ds_read_b64_tr_b16 v[40:41], v31 offset:256
    ds_read_b64_tr_b16 v[42:43], v31 offset:2304
    ds_read_b64_tr_b16 v[44:45], v31 offset:512
    ds_read_b64_tr_b16 v[46:47], v31 offset:2560
    ds_read_b64_tr_b16 v[48:49], v31 offset:768
    ds_read_b64_tr_b16 v[50:51], v31 offset:2816
    ds_read_b64_tr_b16 v[52:53], v31 offset:4352
    ds_read_b64_tr_b16 v[54:55], v31 offset:6400
    ds_read_b64_tr_b16 v[56:57], v31 offset:4608
    ds_read_b64_tr_b16 v[58:59], v31 offset:6656
    ds_read_b64_tr_b16 v[60:61], v31 offset:4864
    ds_read_b64_tr_b16 v[62:63], v31 offset:6912
    s_waitcnt vmcnt(15) lgkmcnt(8)
    v_mfma_f32_32x32x16_bf16 v[80:95], v[40:43], a[0:3], 0
    ds_read_b64_tr_b16 v[2:3], v31 offset:8448
    ds_read_b64_tr_b16 v[4:5], v31 offset:10496
    v_mul_f32 v228, v252, v128
    v_max_f32 v128, v251, v128
    v_mul_f32 v229, v252, v129
    v_max_f32 v129, v251, v129
    v_exp_f32_e64 v228, v228 clamp
    v_mul_f32 v230, v252, v130
    v_max_f32 v130, v251, v130
    v_exp_f32_e64 v229, v229 clamp
    v_mul_f32 v231, v252, v131
    v_max_f32 v131, v251, v131
    v_mfma_f32_32x32x16_bf16 v[96:111], v[44:47], a[0:3], 0
    ds_read_b64_tr_b16 v[6:7], v31 offset:8704
    ds_read_b64_tr_b16 v[8:9], v31 offset:10752
    v_exp_f32_e64 v230, v230 clamp
    v_add_f32 v128, v128, v228
    v_mul_f32 v232, v252, v132
    v_max_f32 v132, v251, v132
    v_exp_f32_e64 v231, v231 clamp
    v_add_f32 v129, v129, v229
    v_mul_f32 v233, v252, v133
    v_max_f32 v133, v251, v133
    v_exp_f32_e64 v232, v232 clamp
    s_waitcnt lgkmcnt(8)
    v_mfma_f32_32x32x16_bf16 v[112:127], v[48:51], a[0:3], 0
    ds_read_b64_tr_b16 v[40:41], v31 offset:8960
    ds_read_b64_tr_b16 v[42:43], v31 offset:11008
    v_add_f32 v130, v130, v230
    s_bfe_u32 s37, s97, 0x80000
    s_cmp_ge_u32 s37, 32
    s_cbranch_scc0 LK_g25
    s_bfe_u32 s37, s36, 0x80000
    s_cmp_ge_u32 s37, 16
    s_cbranch_scc1 LK_gd26
LK_g25:
    s_waitcnt lgkmcnt(0)
    s_bfe_u32 s37, s97, 0x80000
    s_cmp_ge_u32 s37, 32
    s_cbranch_scc0 LK_ga27
    s_bfe_u32 s37, s36, 0x80000
    s_cmp_ge_u32 s37, 16
    s_cbranch_scc1 LK_gd26
LK_ga27:
    s_cmp_eq_u32 s98, 0
    s_cbranch_scc1 LK_gd26
    s_sub_u32 s98, s98, 1
    s_atomic_umax s97, s[24:25], s59 glc
    s_atomic_umax s36, s[24:25], s15 glc
    s_branch LK_g25
LK_gd26:
    buffer_load_dwordx4 v27, s[20:23], s50 offen lds
    buffer_load_dword v246, v35, s[24:27], s33 offen sc1
    buffer_load_dword v247, v35, s[24:27], s32 offen sc1
    buffer_load_dword v176, v244, s[24:27], s99 offen offset:0 sc1
    buffer_load_dword v177, v244, s[24:27], s99 offen offset:256 sc1
    buffer_load_dword v178, v244, s[24:27], s99 offen offset:512 sc1
    buffer_load_dword v179, v244, s[24:27], s99 offen offset:768 sc1
    buffer_load_dwordx4 v[196:199], v34, s[24:27], s54 offen offset:0 sc1
    buffer_load_dwordx4 v[200:203], v34, s[24:27], s54 offen offset:1024 sc1
    buffer_load_dwordx4 v[204:207], v34, s[24:27], s54 offen offset:2048 sc1
    buffer_load_dwordx4 v[208:211], v34, s[24:27], s54 offen offset:3072 sc1
    s_add_u32 s53, s54, 4096
    buffer_load_dwordx4 v[212:215], v34, s[24:27], s53 offen offset:0 sc1
    buffer_load_dwordx4 v[216:219], v34, s[24:27], s53 offen offset:1024 sc1
    buffer_load_dwordx4 v[220:223], v34, s[24:27], s53 offen offset:2048 sc1
    buffer_load_dwordx4 v[224:227], v34, s[24:27], s53 offen offset:3072 sc1
    s_waitcnt vmcnt(29)
    v_mfma_f32_32x32x16_bf16 v[80:95], v[52:55], a[4:7], v[80:95]
    ds_read_b64_tr_b16 v[44:45], v31 offset:12544
    ds_read_b64_tr_b16 v[46:47], v31 offset:14592
    s_lshl_b32 s37, s49, 2
    s_add_u32 s37, s37, s48
    s_lshl_b32 s37, s37, 6
    v_lshrrev_b32 v24, 5, v1
    v_lshl_add_u32 v24, v24, 3, s37
    global_load_dwordx2 v[10:11], v24, s[38:39] offset:0
    global_load_dwordx2 v[12:13], v24, s[38:39] offset:16
    global_load_dwordx2 v[14:15], v24, s[38:39] offset:32
    global_load_dwordx2 v[16:17], v24, s[38:39] offset:48
    s_waitcnt lgkmcnt(8)
    v_mfma_f32_32x32x16_bf16 v[96:111], v[56:59], a[4:7], v[96:111]
    ds_read_b64_tr_b16 v[48:49], v31 offset:12800
    ds_read_b64_tr_b16 v[50:51], v31 offset:14848
    v_mul_f32 v234, v252, v134
    v_max_f32 v134, v251, v134
    v_exp_f32_e64 v233, v233 clamp
    v_add_f32 v131, v131, v231
    v_mul_f32 v235, v252, v135
    v_max_f32 v135, v251, v135
    v_exp_f32_e64 v234, v234 clamp
    v_add_f32 v132, v132, v232
    v_mul_f32 v228, v252, v136
    v_max_f32 v136, v251, v136
    v_mfma_f32_32x32x16_bf16 v[112:127], v[60:63], a[4:7], v[112:127]
    ds_read_b64_tr_b16 v[52:53], v31 offset:13056
    ds_read_b64_tr_b16 v[54:55], v31 offset:15104
    v_exp_f32_e64 v235, v235 clamp
    v_add_f32 v133, v133, v233
    v_mul_f32 v229, v252, v137
    v_max_f32 v137, v251, v137
    v_exp_f32_e64 v228, v228 clamp
    v_add_f32 v134, v134, v234
    v_mul_f32 v230, v252, v138
    v_max_f32 v138, v251, v138
    v_exp_f32_e64 v229, v229 clamp
    s_waitcnt vmcnt(32) lgkmcnt(8)
    v_mfma_f32_32x32x16_bf16 v[80:95], v[2:5], a[8:11], v[80:95]
    ds_read_b64_tr_b16 v[56:57], v29 offset:33024
    ds_read_b64_tr_b16 v[58:59], v29 offset:35072
    v_add_f32 v135, v135, v235
    v_mul_f32 v231, v252, v139
    v_max_f32 v139, v251, v139
    v_exp_f32_e64 v230, v230 clamp
    v_add_f32 v136, v136, v228
    v_mul_f32 v232, v252, v140
    v_max_f32 v140, v251, v140
    v_exp_f32_e64 v231, v231 clamp
    v_add_f32 v137, v137, v229
    v_mul_f32 v233, v252, v141
    v_mfma_f32_32x32x16_bf16 v[96:111], v[6:9], a[8:11], v[96:111]
    ds_read_b64_tr_b16 v[60:61], v29 offset:33280
    ds_read_b64_tr_b16 v[62:63], v29 offset:35328
    s_add_u32 s50, s56, 425984
    s_add_u32 m0, s63, 57344
    s_nop 0
    buffer_load_dwordx4 v27, s[20:23], s50 offen lds
    s_add_u32 s50, s56, 442368
    s_add_u32 m0, s63, 61440
    v_max_f32 v141, v251, v141
    v_exp_f32_e64 v232, v232 clamp
    v_add_f32 v138, v138, v230
    v_mul_f32 v234, v252, v142
    v_max_f32 v142, v251, v142
    v_exp_f32_e64 v233, v233 clamp
    s_waitcnt lgkmcnt(8)
    v_mfma_f32_32x32x16_bf16 v[112:127], v[40:43], a[8:11], v[112:127]
    ds_read_b64_tr_b16 v[2:3], v29 offset:33536
    ds_read_b64_tr_b16 v[4:5], v29 offset:35584
    buffer_load_dwordx4 v27, s[20:23], s50 offen lds
    s_add_u32 s50, s56, 131072
    s_add_u32 m0, s63, 114688
    v_add_f32 v139, v139, v231
    v_mul_f32 v235, v252, v143
    v_max_f32 v143, v251, v143
    v_exp_f32_e64 v234, v234 clamp
    v_add_f32 v140, v140, v232
    v_exp_f32_e64 v235, v235 clamp
    v_add_f32 v141, v141, v233
    s_waitcnt vmcnt(33)
    v_mfma_f32_32x32x16_bf16 v[80:95], v[44:47], a[12:15], v[80:95]
    ds_read_b64_tr_b16 v[6:7], v29 offset:37120
    ds_read_b64_tr_b16 v[8:9], v29 offset:39168
    v_add_f32 v142, v142, v234
    v_add_f32 v143, v143, v235
    v_cvt_pk_bf16_f32 v128, v128, v129
    v_cvt_pk_bf16_f32 v129, v130, v131
    v_cvt_pk_bf16_f32 v130, v132, v133
    v_cvt_pk_bf16_f32 v131, v134, v135
    v_cvt_pk_bf16_f32 v132, v136, v137
    v_cvt_pk_bf16_f32 v133, v138, v139
    v_cvt_pk_bf16_f32 v134, v140, v141
    v_cvt_pk_bf16_f32 v135, v142, v143
    s_waitcnt lgkmcnt(8)
    v_mfma_f32_32x32x16_bf16 v[96:111], v[48:51], a[12:15], v[96:111]
    ds_read_b64_tr_b16 v[40:41], v29 offset:37376
    ds_read_b64_tr_b16 v[42:43], v29 offset:39424
    buffer_load_dwordx4 v27, s[20:23], s50 offen lds
    s_add_u32 s50, s56, 147456
    s_add_u32 m0, s63, 118784
    v_mul_f32 v228, v252, v144
    v_max_f32 v144, v251, v144
    v_mul_f32 v229, v252, v145
    v_max_f32 v145, v251, v145
    v_exp_f32_e64 v228, v228 clamp
    v_mul_f32 v230, v252, v146
    v_max_f32 v146, v251, v146
    v_exp_f32_e64 v229, v229 clamp
    v_mfma_f32_32x32x16_bf16 v[112:127], v[52:55], a[12:15], v[112:127]
    ds_read_b64_tr_b16 v[44:45], v29 offset:37632
    ds_read_b64_tr_b16 v[46:47], v29 offset:39680
    buffer_load_dwordx4 v27, s[20:23], s50 offen lds
    s_add_u32 s50, s56, 163840
    s_add_u32 m0, s63, 122880
    v_mul_f32 v231, v252, v147
    v_max_f32 v147, v251, v147
    v_exp_f32_e64 v230, v230 clamp
    v_add_f32 v144, v144, v228
    v_mul_f32 v232, v252, v148
    v_max_f32 v148, v251, v148
    v_exp_f32_e64 v231, v231 clamp
    s_waitcnt vmcnt(34) lgkmcnt(8)
    v_mfma_f32_32x32x16_bf16 v[80:95], v[56:59], a[16:19], v[80:95]
    ds_read_b64_tr_b16 v[48:49], v29 offset:41216
    ds_read_b64_tr_b16 v[50:51], v29 offset:43264
    buffer_load_dwordx4 v27, s[20:23], s50 offen lds
    s_add_u32 s50, s56, 180224
    s_add_u32 m0, s63, 126976
    v_add_f32 v145, v145, v229
    v_mul_f32 v233, v252, v149
    v_max_f32 v149, v251, v149
    v_exp_f32_e64 v232, v232 clamp
    v_add_f32 v146, v146, v230
    v_mul_f32 v234, v252, v150
    v_max_f32 v150, v251, v150
    v_exp_f32_e64 v233, v233 clamp
    v_mfma_f32_32x32x16_bf16 v[96:111], v[60:63], a[16:19], v[96:111]
    ds_read_b64_tr_b16 v[52:53], v29 offset:41472
    ds_read_b64_tr_b16 v[54:55], v29 offset:43520
    buffer_load_dwordx4 v27, s[20:23], s50 offen lds
    s_add_u32 s50, s56, 196608
    s_add_u32 m0, s63, 0
    v_add_f32 v147, v147, v231
    v_mul_f32 v235, v252, v151
    v_max_f32 v151, v251, v151
    v_exp_f32_e64 v234, v234 clamp
    v_add_f32 v148, v148, v232
    v_mul_f32 v228, v252, v152
    v_max_f32 v152, v251, v152
    v_exp_f32_e64 v235, v235 clamp
    s_waitcnt lgkmcnt(8)
    v_mfma_f32_32x32x16_bf16 v[112:127], v[2:5], a[16:19], v[112:127]
    ds_read_b64_tr_b16 v[56:57], v29 offset:41728
    ds_read_b64_tr_b16 v[58:59], v29 offset:43776
    buffer_load_dwordx4 v27, s[20:23], s50 offen lds
    s_add_u32 s50, s56, 212992
    s_add_u32 m0, s63, 4096
    v_add_f32 v149, v149, v233
    s_waitcnt vmcnt(18)
    v_mfma_f32_32x32x16_bf16 v[160:175], v[188:191], v[196:199], 0
    v_mul_f32 v229, v252, v153
    v_max_f32 v153, v251, v153
    v_exp_f32_e64 v228, v228 clamp
    v_add_f32 v150, v150, v234
    v_mul_f32 v230, v252, v154
    s_waitcnt vmcnt(17)
    v_mfma_f32_32x32x16_bf16 v[160:175], v[188:191], v[200:203], v[160:175]
    v_max_f32 v154, v251, v154
    v_exp_f32_e64 v229, v229 clamp
    v_add_f32 v151, v151, v235
    v_mul_f32 v231, v252, v155
    v_max_f32 v155, v251, v155
    v_add_f32 v176, v176, v177
    v_add_f32 v178, v178, v179
    v_add_f32 v176, v176, v178
    v_mov_b32 v177, v176
    s_waitcnt vmcnt(16)
    v_mfma_f32_32x32x16_bf16 v[160:175], v[188:191], v[204:207], v[160:175]
    v_exp_f32_e64 v230, v230 clamp
    v_add_f32 v152, v152, v228
    v_mul_f32 v232, v252, v156
    v_max_f32 v156, v251, v156
    v_exp_f32_e64 v231, v231 clamp
    s_waitcnt vmcnt(15)
    v_mfma_f32_32x32x16_bf16 v[80:95], v[6:9], a[20:23], v[80:95]
    ds_read_b64_tr_b16 v[60:61], v29 offset:45312
    ds_read_b64_tr_b16 v[62:63], v29 offset:47360
    v_mfma_f32_32x32x16_bf16 v[160:175], v[188:191], v[208:211], v[160:175]
    v_add_f32 v153, v153, v229
    v_mul_f32 v233, v252, v157
    v_max_f32 v157, v251, v157
    v_exp_f32_e64 v232, v232 clamp
    v_add_f32 v154, v154, v230
    v_permlane32_swap_b32 v176, v177
    v_add_f32 v176, v176, v177
    ds_write_b32 v242, v176
    s_waitcnt vmcnt(14)
    v_mfma_f32_32x32x16_bf16 v[160:175], v[188:191], v[212:215], v[160:175]
    v_mul_f32 v234, v252, v158
    v_max_f32 v158, v251, v158
    v_exp_f32_e64 v233, v233 clamp
    v_add_f32 v155, v155, v231
    v_mul_f32 v235, v252, v159
    s_waitcnt vmcnt(13)
    v_mfma_f32_32x32x16_bf16 v[160:175], v[188:191], v[216:219], v[160:175]
    v_max_f32 v159, v251, v159
    v_exp_f32_e64 v234, v234 clamp
    v_add_f32 v156, v156, v232
    v_exp_f32_e64 v235, v235 clamp
    v_add_f32 v157, v157, v233
    s_waitcnt vmcnt(12)
    v_mfma_f32_32x32x16_bf16 v[160:175], v[188:191], v[220:223], v[160:175]
    v_add_f32 v158, v158, v234
    v_add_f32 v159, v159, v235
    v_cvt_pk_bf16_f32 v144, v144, v145
    v_cvt_pk_bf16_f32 v145, v146, v147
    v_cvt_pk_bf16_f32 v146, v148, v149
    s_waitcnt vmcnt(11)
    v_mfma_f32_32x32x16_bf16 v[160:175], v[188:191], v[224:227], v[160:175]
    v_cvt_pk_bf16_f32 v147, v150, v151
    v_cvt_pk_bf16_f32 v148, v152, v153
    v_cvt_pk_bf16_f32 v149, v154, v155
    v_cvt_pk_bf16_f32 v150, v156, v157
    v_cvt_pk_bf16_f32 v151, v158, v159
    s_nop 6
    ds_write_b128 v240, v[160:163]
    ds_write_b128 v240, v[164:167] offset:1024
    s_waitcnt lgkmcnt(0)
    s_barrier
    ds_read_b128 v[168:171], v241
    ds_read_b128 v[172:175], v241 offset:1024
    ds_read_b128 v[196:199], v243
    ds_read_b128 v[200:203], v243 offset:32
    ds_read_b128 v[204:207], v243 offset:512
    ds_read_b128 v[208:211], v243 offset:544
    s_waitcnt lgkmcnt(0)
    v_pk_add_f32 v[160:161], v[160:161], v[168:169]
    v_pk_add_f32 v[196:197], v[196:197], v[204:205]
    v_pk_add_f32 v[162:163], v[162:163], v[170:171]
    v_pk_add_f32 v[198:199], v[198:199], v[206:207]
    v_pk_add_f32 v[164:165], v[164:165], v[172:173]
    v_pk_add_f32 v[200:201], v[200:201], v[208:209]
    v_pk_add_f32 v[166:167], v[166:167], v[174:175]
    v_pk_add_f32 v[202:203], v[202:203], v[210:211]
    v_cvt_pk_bf16_f32 v160, v160, v161
    v_cvt_pk_bf16_f32 v196, v196, v197
    v_cvt_pk_bf16_f32 v161, v162, v163
    v_cvt_pk_bf16_f32 v197, v198, v199
    v_cvt_pk_bf16_f32 v162, v164, v165
    v_cvt_pk_bf16_f32 v198, v200, v201
    v_cvt_pk_bf16_f32 v163, v166, v167
    v_cvt_pk_bf16_f32 v199, v202, v203
    v_cndmask_b32 v136, v196, v160, vcc
    v_cndmask_b32 v137, v197, v161, vcc
    v_cndmask_b32 v138, v198, v162, vcc
    v_cndmask_b32 v139, v199, v163, vcc
    v_cndmask_b32 v140, v160, v196, vcc
    v_cndmask_b32 v141, v161, v197, vcc
    v_cndmask_b32 v142, v162, v198, vcc
    v_cndmask_b32 v143, v163, v199, vcc
    v_mfma_f32_32x32x16_bf16 v[160:175], v[136:139], v[128:131], 0
    v_mfma_f32_32x32x16_bf16 v[196:211], v[136:139], v[144:147], 0
    v_mfma_f32_32x32x16_bf16 v[212:227], v[140:143], v[132:135], 0
    v_mfma_f32_32x32x16_bf16 v[228:243], v[140:143], v[148:151], 0
    s_nop 8
    v_add_f32 v168, v251, v168
    v_rcp_f32 v168, v168
    s_nop 0
    v_mul_f32 v168, v168, v246
    v_pk_mul_f32 v[160:161], v[160:161], v[168:169] op_sel_hi:[1,0]
    v_pk_mul_f32 v[162:163], v[162:163], v[168:169] op_sel_hi:[1,0]
    v_pk_mul_f32 v[164:165], v[164:165], v[168:169] op_sel_hi:[1,0]
    v_pk_mul_f32 v[166:167], v[166:167], v[168:169] op_sel_hi:[1,0]
    v_cvt_pk_bf16_f32 v160, v160, v161
    v_cvt_pk_bf16_f32 v161, v162, v163
    v_cvt_pk_bf16_f32 v162, v164, v165
    v_cvt_pk_bf16_f32 v163, v166, v167
    buffer_store_dwordx4 v[160:163], v32, s[24:27], s3 offen sc1
    v_add_f32 v204, v251, v204
    v_rcp_f32 v204, v204
    s_nop 0
    v_mul_f32 v204, v204, v247
    v_pk_mul_f32 v[196:197], v[196:197], v[204:205] op_sel_hi:[1,0]
    v_pk_mul_f32 v[198:199], v[198:199], v[204:205] op_sel_hi:[1,0]
    v_pk_mul_f32 v[200:201], v[200:201], v[204:205] op_sel_hi:[1,0]
    v_pk_mul_f32 v[202:203], v[202:203], v[204:205] op_sel_hi:[1,0]
    v_cvt_pk_bf16_f32 v196, v196, v197
    v_cvt_pk_bf16_f32 v197, v198, v199
    v_cvt_pk_bf16_f32 v198, v200, v201
    v_cvt_pk_bf16_f32 v199, v202, v203
    buffer_store_dwordx4 v[196:199], v33, s[24:27], s3 offen sc1
    v_add_f32 v212, v251, v212
    v_rcp_f32 v212, v212
    s_nop 0
    v_mul_f32 v212, v212, v246
    v_pk_mul_f32 v[220:221], v[220:221], v[212:213] op_sel_hi:[1,0]
    v_pk_mul_f32 v[222:223], v[222:223], v[212:213] op_sel_hi:[1,0]
    v_pk_mul_f32 v[224:225], v[224:225], v[212:213] op_sel_hi:[1,0]
    v_pk_mul_f32 v[226:227], v[226:227], v[212:213] op_sel_hi:[1,0]
    v_cvt_pk_bf16_f32 v220, v220, v221
    v_cvt_pk_bf16_f32 v221, v222, v223
    v_cvt_pk_bf16_f32 v222, v224, v225
    v_cvt_pk_bf16_f32 v223, v226, v227
    buffer_store_dwordx4 v[220:223], v32, s[24:27], s2 offen sc1
    v_add_f32 v228, v251, v228
    v_rcp_f32 v228, v228
    s_nop 0
    v_mul_f32 v228, v228, v247
    v_pk_mul_f32 v[236:237], v[236:237], v[228:229] op_sel_hi:[1,0]
    v_pk_mul_f32 v[238:239], v[238:239], v[228:229] op_sel_hi:[1,0]
    v_pk_mul_f32 v[240:241], v[240:241], v[228:229] op_sel_hi:[1,0]
    v_pk_mul_f32 v[242:243], v[242:243], v[228:229] op_sel_hi:[1,0]
    v_cvt_pk_bf16_f32 v236, v236, v237
    v_cvt_pk_bf16_f32 v237, v238, v239
    v_cvt_pk_bf16_f32 v238, v240, v241
    v_cvt_pk_bf16_f32 v239, v242, v243
    buffer_store_dwordx4 v[236:239], v33, s[24:27], s2 offen sc1
    s_mov_b32 s60, 0
    s_branch LK_po45
LK_ph32:
    s_waitcnt vmcnt(5)
    s_atomic_add s1, s[24:25], s58
    s_brev_b32 s60, 1
    s_branch LK_ps31
LK_ph34:
    s_waitcnt vmcnt(7)
    s_atomic_add s1, s[24:25], s58
    s_brev_b32 s60, 1
    s_branch LK_ps33
LK_ph36:
    s_waitcnt vmcnt(8)
    s_atomic_add s1, s[24:25], s58
    s_brev_b32 s60, 1
    s_branch LK_ps35
LK_ph38:
    s_waitcnt vmcnt(11)
    s_atomic_add s1, s[24:25], s58
    s_brev_b32 s60, 1
    s_branch LK_ps37
LK_ph40:
    s_waitcnt vmcnt(13)
    s_atomic_add s1, s[24:25], s58
    s_brev_b32 s60, 1
    s_branch LK_ps39
LK_ph42:
    s_waitcnt vmcnt(16)
    s_atomic_add s1, s[24:25], s58
    s_brev_b32 s60, 1
    s_branch LK_ps41
LK_ph44:
    s_waitcnt vmcnt(17)
    s_atomic_add s1, s[24:25], s58
    s_branch LK_pf43
LK_po45:
    buffer_load_dwordx4 v27, s[20:23], s50 offen lds
    s_add_u32 s50, s56, 229376
    s_add_u32 m0, s63, 8192
    s_atomic_umax s96, s[24:25], s58 glc
    v_mfma_f32_32x32x16_bf16 v[96:111], v[40:43], a[20:23], v[96:111]
    ds_read_b64_tr_b16 v[2:3], v29 offset:45568
    ds_read_b64_tr_b16 v[4:5], v29 offset:47616
    buffer_load_dwordx4 v27, s[20:23], s50 offen lds
    s_add_u32 s50, s56, 245760
    s_add_u32 m0, s63, 12288
    v_mfma_f32_32x32x16_bf16 v[112:127], v[44:47], a[20:23], v[112:127]
    ds_read_b64_tr_b16 v[6:7], v29 offset:45824
    ds_read_b64_tr_b16 v[8:9], v29 offset:47872
    buffer_load_dwordx4 v27, s[20:23], s50 offen lds
    s_add_u32 s50, s56, 262144
    s_add_u32 m0, s63, 65536
    v_mfma_f32_32x32x16_bf16 v[80:95], v[48:51], a[24:27], v[80:95]
    ds_read_b64_tr_b16 v[40:41], v30 offset:33024
    ds_read_b64_tr_b16 v[42:43], v30 offset:35072
    buffer_load_dwordx4 v27, s[20:23], s50 offen lds
    s_add_u32 s50, s56, 278528
    s_add_u32 m0, s63, 69632
    v_mfma_f32_32x32x16_bf16 v[96:111], v[52:55], a[24:27], v[96:111]
    ds_read_b64_tr_b16 v[44:45], v30 offset:33280
    ds_read_b64_tr_b16 v[46:47], v30 offset:35328
    buffer_load_dwordx4 v27, s[20:23], s50 offen lds
    s_add_u32 s50, s56, 294912
    s_add_u32 m0, s63, 73728
    v_mfma_f32_32x32x16_bf16 v[112:127], v[56:59], a[24:27], v[112:127]
    ds_read_b64_tr_b16 v[48:49], v30 offset:33536
    ds_read_b64_tr_b16 v[50:51], v30 offset:35584
    v_mfma_f32_32x32x16_bf16 v[80:95], v[60:63], a[28:31], v[80:95]
    ds_read_b64_tr_b16 v[52:53], v30 offset:37120
    ds_read_b64_tr_b16 v[54:55], v30 offset:39168
    s_barrier
    s_waitcnt lgkmcnt(8)
    v_mfma_f32_32x32x16_bf16 v[96:111], v[2:5], a[28:31], v[96:111]
    ds_read_b64_tr_b16 v[56:57], v30 offset:37376
    ds_read_b64_tr_b16 v[58:59], v30 offset:39424
    v_mfma_f32_32x32x16_bf16 v[112:127], v[6:9], a[28:31], v[112:127]
    ds_read_b64_tr_b16 v[60:61], v30 offset:37632
    ds_read_b64_tr_b16 v[62:63], v30 offset:39680
    s_waitcnt lgkmcnt(8)
    v_mfma_f32_32x32x16_bf16 v[80:95], v[40:43], a[32:35], v[80:95]
    ds_read_b64_tr_b16 v[2:3], v30 offset:41216
    ds_read_b64_tr_b16 v[4:5], v30 offset:43264
    v_mfma_f32_32x32x16_bf16 v[96:111], v[44:47], a[32:35], v[96:111]
    ds_read_b64_tr_b16 v[6:7], v30 offset:41472
    ds_read_b64_tr_b16 v[8:9], v30 offset:43520
    s_waitcnt lgkmcnt(8)
    v_mfma_f32_32x32x16_bf16 v[112:127], v[48:51], a[32:35], v[112:127]
    ds_read_b64_tr_b16 v[40:41], v30 offset:41728
    ds_read_b64_tr_b16 v[42:43], v30 offset:43776
    v_mfma_f32_32x32x16_bf16 v[80:95], v[52:55], a[36:39], v[80:95]
    ds_read_b64_tr_b16 v[44:45], v30 offset:45312
    ds_read_b64_tr_b16 v[46:47], v30 offset:47360
    s_waitcnt lgkmcnt(8)
    v_mfma_f32_32x32x16_bf16 v[96:111], v[56:59], a[36:39], v[96:111]
    ds_read_b64_tr_b16 v[48:49], v30 offset:45568
    ds_read_b64_tr_b16 v[50:51], v30 offset:47616
    v_mfma_f32_32x32x16_bf16 v[112:127], v[60:63], a[36:39], v[112:127]
    ds_read_b64_tr_b16 v[52:53], v30 offset:45824
    ds_read_b64_tr_b16 v[54:55], v30 offset:47872
    s_bfe_u32 s37, s96, 0x80008
    s_cmp_ge_u32 s37, 4
    s_cbranch_scc1 LK_gd29
LK_g28:
    s_waitcnt lgkmcnt(0)
    s_bfe_u32 s37, s96, 0x80008
    s_cmp_ge_u32 s37, 4
    s_cbranch_scc1 LK_gd29
LK_ga30:
    s_cmp_eq_u32 s98, 0
    s_cbranch_scc1 LK_gd29
    s_sub_u32 s98, s98, 1
    s_getreg_b32 s37, hwreg(HW_REG_IB_STS)
    s_and_b32 s37, s37, 0xc0000f
    s_or_b32 s37, s37, s60
    s_cmp_le_u32 s37, 0x5
    s_cbranch_scc1 LK_ph32
LK_ps31:
    s_atomic_umax s96, s[24:25], s58 glc
    s_branch LK_g28
LK_gd29:
    buffer_load_dwordx4 v27, s[20:23], s50 offen lds
    s_add_u32 s53, s56, 131072
    buffer_load_dwordx4 a[64:67], v32, s[24:27], s53 offen sc1
    s_add_u32 s53, s56, 147456
    s_waitcnt vmcnt(12)
    s_barrier
    s_waitcnt lgkmcnt(8)
    v_mfma_f32_32x32x16_bf16 v[80:95], v[2:5], a[40:43], v[80:95]
    ds_read_b64_tr_b16 v[56:57], v29 offset:49408
    ds_read_b64_tr_b16 v[58:59], v29 offset:51456
    v_mfma_f32_32x32x16_bf16 v[96:111], v[6:9], a[40:43], v[96:111]
    ds_read_b64_tr_b16 v[60:61], v29 offset:49664
    ds_read_b64_tr_b16 v[62:63], v29 offset:51712
    v_sub_f32 v244, 1.0, v246
    v_cvt_pk_bf16_f32 v244, v244, v244
    v_lshlrev_b32 v244, 16, v244
    s_waitcnt lgkmcnt(8)
    v_mfma_f32_32x32x16_bf16 v[112:127], v[40:43], a[40:43], v[112:127]
    ds_read_b64_tr_b16 v[2:3], v29 offset:49920
    ds_read_b64_tr_b16 v[4:5], v29 offset:51968
    v_lshlrev_b32 v228, 16, v10
    v_and_b32 v229, v254, v10
    v_lshlrev_b32 v230, 16, v11
    v_and_b32 v231, v254, v11
    v_mfma_f32_32x32x16_bf16 v[80:95], v[44:47], a[44:47], v[80:95]
    ds_read_b64_tr_b16 v[6:7], v29 offset:53504
    ds_read_b64_tr_b16 v[8:9], v29 offset:55552
    s_getreg_b32 s37, hwreg(HW_REG_IB_STS)
    s_and_b32 s37, s37, 0xc0000f
    s_or_b32 s37, s37, s60
    s_cmp_le_u32 s37, 0x7
    s_cbranch_scc1 LK_ph34
LK_ps33:
    s_waitcnt lgkmcnt(8)
    v_mfma_f32_32x32x16_bf16 v[96:111], v[48:51], a[44:47], v[96:111]
    ds_read_b64_tr_b16 v[40:41], v29 offset:53760
    ds_read_b64_tr_b16 v[42:43], v29 offset:55808
    v_lshlrev_b32 v232, 16, v12
    v_and_b32 v233, v254, v12
    v_lshlrev_b32 v234, 16, v13
    v_and_b32 v235, v254, v13
    v_mfma_f32_32x32x16_bf16 v[112:127], v[52:55], a[44:47], v[112:127]
    ds_read_b64_tr_b16 v[44:45], v29 offset:54016
    ds_read_b64_tr_b16 v[46:47], v29 offset:56064
    v_lshlrev_b32 v236, 16, v14
    v_and_b32 v237, v254, v14
    v_lshlrev_b32 v238, 16, v15
    v_and_b32 v239, v254, v15
    s_waitcnt lgkmcnt(8)
    v_mfma_f32_32x32x16_bf16 v[80:95], v[56:59], a[48:51], v[80:95]
    ds_read_b64_tr_b16 v[48:49], v29 offset:57600
    ds_read_b64_tr_b16 v[50:51], v29 offset:59648
    v_lshlrev_b32 v240, 16, v16
    v_and_b32 v241, v254, v16
    v_lshlrev_b32 v242, 16, v17
    v_and_b32 v243, v254, v17
    v_mfma_f32_32x32x16_bf16 v[96:111], v[60:63], a[48:51], v[96:111]
    ds_read_b64_tr_b16 v[52:53], v29 offset:57856
    ds_read_b64_tr_b16 v[54:55], v29 offset:59904
    s_waitcnt lgkmcnt(8)
    v_mfma_f32_32x32x16_bf16 v[112:127], v[2:5], a[48:51], v[112:127]
    ds_read_b64_tr_b16 v[56:57], v29 offset:58112
    ds_read_b64_tr_b16 v[58:59], v29 offset:60160
    buffer_load_dwordx4 a[68:71], v32, s[24:27], s53 offen sc1
    s_add_u32 s53, s56, 163840
    v_mfma_f32_32x32x16_bf16 v[80:95], v[6:9], a[52:55], v[80:95]
    ds_read_b64_tr_b16 v[60:61], v29 offset:61696
    ds_read_b64_tr_b16 v[62:63], v29 offset:63744
    s_getreg_b32 s37, hwreg(HW_REG_IB_STS)
    s_and_b32 s37, s37, 0xc0000f
    s_or_b32 s37, s37, s60
    s_cmp_le_u32 s37, 0x8
    s_cbranch_scc1 LK_ph36
LK_ps35:
    s_waitcnt lgkmcnt(8)
    v_mfma_f32_32x32x16_bf16 v[96:111], v[40:43], a[52:55], v[96:111]
    ds_read_b64_tr_b16 v[2:3], v29 offset:61952
    ds_read_b64_tr_b16 v[4:5], v29 offset:64000
    buffer_load_dwordx4 a[72:75], v32, s[24:27], s53 offen sc1
    s_add_u32 s53, s56, 180224
    v_mfma_f32_32x32x16_bf16 v[112:127], v[44:47], a[52:55], v[112:127]
    ds_read_b64_tr_b16 v[6:7], v29 offset:62208
    ds_read_b64_tr_b16 v[8:9], v29 offset:64256
    s_waitcnt lgkmcnt(8)
    v_mfma_f32_32x32x16_bf16 v[80:95], v[48:51], a[56:59], v[80:95]
    ds_read_b64_tr_b16 v[40:41], v31 offset:0
    ds_read_b64_tr_b16 v[42:43], v31 offset:2048
    buffer_load_dwordx4 a[76:79], v32, s[24:27], s53 offen sc1
    s_add_u32 s53, s56, 196608
    v_mfma_f32_32x32x16_bf16 v[96:111], v[52:55], a[56:59], v[96:111]
    ds_read_b64_tr_b16 v[44:45], v31 offset:4096
    ds_read_b64_tr_b16 v[46:47], v31 offset:6144
    s_waitcnt lgkmcnt(8)
    v_mfma_f32_32x32x16_bf16 v[112:127], v[56:59], a[56:59], v[112:127]
    ds_read_b64_tr_b16 v[48:49], v31 offset:8192
    ds_read_b64_tr_b16 v[50:51], v31 offset:10240
    buffer_load_dwordx4 a[80:83], v32, s[24:27], s53 offen sc1
    s_add_u32 s53, s56, 212992
    v_mfma_f32_32x32x16_bf16 v[80:95], v[60:63], a[60:63], v[80:95]
    ds_read_b64_tr_b16 v[52:53], v31 offset:12288
    ds_read_b64_tr_b16 v[54:55], v31 offset:14336
    s_getreg_b32 s37, hwreg(HW_REG_IB_STS)
    s_and_b32 s37, s37, 0xc0000f
    s_or_b32 s37, s37, s60
    s_cmp_le_u32 s37, 0xb
    s_cbranch_scc1 LK_ph38
LK_ps37:
    s_waitcnt lgkmcnt(8)
    v_mfma_f32_32x32x16_bf16 v[96:111], v[2:5], a[60:63], v[96:111]
    ds_read_b64_tr_b16 v[56:57], v29 offset:32768
    ds_read_b64_tr_b16 v[58:59], v29 offset:34816
    buffer_load_dwordx4 a[84:87], v32, s[24:27], s53 offen sc1
    s_add_u32 s53, s56, 229376
    v_mfma_f32_32x32x16_bf16 v[112:127], v[6:9], a[60:63], v[112:127]
    ds_read_b64_tr_b16 v[60:61], v29 offset:36864
    ds_read_b64_tr_b16 v[62:63], v29 offset:38912
    s_waitcnt lgkmcnt(8)
    v_mfma_f32_32x32x16_bf16 v[64:79], v[40:43], a[0:3], 0
    ds_read_b64_tr_b16 v[2:3], v29 offset:40960
    ds_read_b64_tr_b16 v[4:5], v29 offset:43008
    buffer_load_dwordx4 a[88:91], v32, s[24:27], s53 offen sc1
    s_add_u32 s53, s56, 245760
    v_mfma_f32_32x32x16_bf16 v[64:79], v[44:47], a[4:7], v[64:79]
    ds_read_b64_tr_b16 v[6:7], v29 offset:45056
    ds_read_b64_tr_b16 v[8:9], v29 offset:47104
    s_waitcnt lgkmcnt(8)
    v_mfma_f32_32x32x16_bf16 v[64:79], v[48:51], a[8:11], v[64:79]
    ds_read_b64_tr_b16 v[40:41], v30 offset:32768
    ds_read_b64_tr_b16 v[42:43], v30 offset:34816
    s_getreg_b32 s37, hwreg(HW_REG_IB_STS)
    s_and_b32 s37, s37, 0xc0000f
    s_or_b32 s37, s37, s60
    s_cmp_le_u32 s37, 0xd
    s_cbranch_scc1 LK_ph40
LK_ps39:
    v_mfma_f32_32x32x16_bf16 v[64:79], v[52:55], a[12:15], v[64:79]
    ds_read_b64_tr_b16 v[44:45], v30 offset:36864
    ds_read_b64_tr_b16 v[46:47], v30 offset:38912
    buffer_load_dwordx4 a[92:95], v32, s[24:27], s53 offen sc1
    s_add_u32 s53, s56, 262144
    s_waitcnt lgkmcnt(8)
    v_mfma_f32_32x32x16_bf16 v[64:79], v[56:59], a[16:19], v[64:79]
    ds_read_b64_tr_b16 v[48:49], v30 offset:49408
    ds_read_b64_tr_b16 v[50:51], v30 offset:51456
    v_mfma_f32_32x32x16_bf16 v[64:79], v[60:63], a[20:23], v[64:79]
    ds_read_b64_tr_b16 v[52:53], v30 offset:49664
    ds_read_b64_tr_b16 v[54:55], v30 offset:51712
    buffer_load_dwordx4 a[96:99], v32, s[24:27], s53 offen sc1
    s_add_u32 s53, s56, 278528
    s_waitcnt lgkmcnt(8)
    v_mfma_f32_32x32x16_bf16 v[64:79], v[2:5], a[24:27], v[64:79]
    ds_read_b64_tr_b16 v[56:57], v30 offset:49920
    ds_read_b64_tr_b16 v[58:59], v30 offset:51968
    v_mfma_f32_32x32x16_bf16 v[64:79], v[6:9], a[28:31], v[64:79]
    ds_read_b64_tr_b16 v[60:61], v30 offset:53504
    ds_read_b64_tr_b16 v[62:63], v30 offset:55552
    buffer_load_dwordx4 a[100:103], v32, s[24:27], s53 offen sc1
    s_add_u32 s53, s56, 294912
    s_waitcnt lgkmcnt(8)
    v_mfma_f32_32x32x16_bf16 v[64:79], v[40:43], a[32:35], v[64:79]
    ds_read_b64_tr_b16 v[2:3], v30 offset:53760
    ds_read_b64_tr_b16 v[4:5], v30 offset:55808
    s_getreg_b32 s37, hwreg(HW_REG_IB_STS)
    s_and_b32 s37, s37, 0xc0000f
    s_or_b32 s37, s37, s60
    s_cmp_le_u32 s37, 0x400000
    s_cbranch_scc1 LK_ph42
LK_ps41:
    v_mfma_f32_32x32x16_bf16 v[64:79], v[44:47], a[36:39], v[64:79]
    ds_read_b64_tr_b16 v[6:7], v30 offset:54016
    ds_read_b64_tr_b16 v[8:9], v30 offset:56064
    buffer_load_dwordx4 a[104:107], v32, s[24:27], s53 offen sc1
    s_add_u32 s53, s56, 311296
    s_waitcnt vmcnt(10)
    s_cmp_eq_u32 s60, 0
    s_cbranch_scc1 LK_ph44
LK_pf43:
    s_waitcnt lgkmcnt(8)
    v_mfma_f32_32x32x16_bf16 v[80:95], v[48:51], a[64:67], v[80:95]
    ds_read_b64_tr_b16 v[40:41], v30 offset:57600
    ds_read_b64_tr_b16 v[42:43], v30 offset:59648
    v_mfma_f32_32x32x16_bf16 v[96:111], v[52:55], a[64:67], v[96:111]
    ds_read_b64_tr_b16 v[44:45], v30 offset:57856
    ds_read_b64_tr_b16 v[46:47], v30 offset:59904
    buffer_load_dwordx4 a[108:111], v32, s[24:27], s53 offen sc1
    s_add_u32 s50, s56, 311296
    s_add_u32 m0, s63, 77824
    s_waitcnt lgkmcnt(8)
    v_mfma_f32_32x32x16_bf16 v[112:127], v[56:59], a[64:67], v[112:127]
    ds_read_b64_tr_b16 v[48:49], v30 offset:58112
    ds_read_b64_tr_b16 v[50:51], v30 offset:60160
    s_waitcnt vmcnt(10)
    v_mfma_f32_32x32x16_bf16 v[80:95], v[60:63], a[68:71], v[80:95]
    ds_read_b64_tr_b16 v[52:53], v30 offset:61696
    ds_read_b64_tr_b16 v[54:55], v30 offset:63744
    buffer_load_dwordx4 v27, s[20:23], s50 offen lds
    s_add_u32 s50, s57, 0
    s_add_u32 m0, s63, 16384
    s_waitcnt lgkmcnt(8)
    v_mfma_f32_32x32x16_bf16 v[96:111], v[2:5], a[68:71], v[96:111]
    ds_read_b64_tr_b16 v[56:57], v30 offset:61952
    ds_read_b64_tr_b16 v[58:59], v30 offset:64000
    v_mfma_f32_32x32x16_bf16 v[112:127], v[6:9], a[68:71], v[112:127]
    ds_read_b64_tr_b16 v[60:61], v30 offset:62208
    ds_read_b64_tr_b16 v[62:63], v30 offset:64256
    buffer_load_dwordx4 v27, s[16:19], s50 offen lds
    s_add_u32 s50, s57, 16384
    s_add_u32 m0, s63, 20480
    s_barrier
    s_waitcnt vmcnt(11) lgkmcnt(8)
    v_mfma_f32_32x32x16_bf16 v[80:95], v[40:43], a[72:75], v[80:95]
    ds_read_b64_tr_b16 v[2:3], v29 offset:256
    ds_read_b64_tr_b16 v[4:5], v29 offset:2304
    v_mfma_f32_32x32x16_bf16 v[96:111], v[44:47], a[72:75], v[96:111]
    ds_read_b64_tr_b16 v[6:7], v29 offset:512
    ds_read_b64_tr_b16 v[8:9], v29 offset:2560
    s_atomic_umax s96, s[24:25], s58 glc
    s_waitcnt lgkmcnt(8)
    v_mfma_f32_32x32x16_bf16 v[112:127], v[48:51], a[72:75], v[112:127]
    ds_read_b64_tr_b16 v[40:41], v29 offset:768
    ds_read_b64_tr_b16 v[42:43], v29 offset:2816
    buffer_load_dwordx4 v27, s[16:19], s50 offen lds
    s_add_u32 s50, s57, 32768
    s_add_u32 m0, s63, 24576
    s_waitcnt vmcnt(11)
    v_mfma_f32_32x32x16_bf16 v[80:95], v[52:55], a[76:79], v[80:95]
    ds_read_b64_tr_b16 v[44:45], v29 offset:4352
    ds_read_b64_tr_b16 v[46:47], v29 offset:6400
    s_waitcnt lgkmcnt(8)
    v_mfma_f32_32x32x16_bf16 v[96:111], v[56:59], a[76:79], v[96:111]
    ds_read_b64_tr_b16 v[48:49], v29 offset:4608
    ds_read_b64_tr_b16 v[50:51], v29 offset:6656
    buffer_load_dwordx4 v27, s[16:19], s50 offen lds
    s_add_u32 s50, s57, 49152
    s_add_u32 m0, s63, 28672
    v_mfma_f32_32x32x16_bf16 v[112:127], v[60:63], a[76:79], v[112:127]
    ds_read_b64_tr_b16 v[52:53], v29 offset:4864
    ds_read_b64_tr_b16 v[54:55], v29 offset:6912
    s_waitcnt vmcnt(11) lgkmcnt(8)
    v_mfma_f32_32x32x16_bf16 v[80:95], v[2:5], a[80:83], v[80:95]
    ds_read_b64_tr_b16 v[56:57], v29 offset:8448
    ds_read_b64_tr_b16 v[58:59], v29 offset:10496
    buffer_load_dwordx4 v27, s[16:19], s50 offen lds
    s_add_u32 s50, s57, 65536
    s_add_u32 m0, s63, 81920
    v_mfma_f32_32x32x16_bf16 v[96:111], v[6:9], a[80:83], v[96:111]
    ds_read_b64_tr_b16 v[60:61], v29 offset:8704
    ds_read_b64_tr_b16 v[62:63], v29 offset:10752
    s_waitcnt lgkmcnt(8)
    v_mfma_f32_32x32x16_bf16 v[112:127], v[40:43], a[80:83], v[112:127]
    ds_read_b64_tr_b16 v[2:3], v29 offset:8960
    ds_read_b64_tr_b16 v[4:5], v29 offset:11008
    buffer_load_dwordx4 v27, s[16:19], s50 offen lds
    s_add_u32 s50, s57, 81920
    s_add_u32 m0, s63, 86016
    s_waitcnt vmcnt(12)
    v_mfma_f32_32x32x16_bf16 v[80:95], v[44:47], a[84:87], v[80:95]
    ds_read_b64_tr_b16 v[6:7], v29 offset:12544
    ds_read_b64_tr_b16 v[8:9], v29 offset:14592
    s_waitcnt lgkmcnt(8)
    v_mfma_f32_32x32x16_bf16 v[96:111], v[48:51], a[84:87], v[96:111]
    ds_read_b64_tr_b16 v[40:41], v29 offset:12800
    ds_read_b64_tr_b16 v[42:43], v29 offset:14848
    v_mfma_f32_32x32x16_bf16 v[112:127], v[52:55], a[84:87], v[112:127]
    ds_read_b64_tr_b16 v[44:45], v29 offset:13056
    ds_read_b64_tr_b16 v[46:47], v29 offset:15104
    buffer_load_dwordx4 v27, s[16:19], s50 offen lds
    s_add_u32 s50, s57, 98304
    s_add_u32 m0, s63, 90112
    s_waitcnt vmcnt(6)
    s_barrier
    s_waitcnt lgkmcnt(8)
    v_mfma_f32_32x32x16_bf16 v[80:95], v[56:59], a[88:91], v[80:95]
    ds_read_b64_tr_b16 v[48:49], v30 offset:256
    ds_read_b64_tr_b16 v[50:51], v30 offset:2304
    buffer_load_dwordx4 v27, s[16:19], s50 offen lds
    s_add_u32 s50, s57, 114688
    s_add_u32 m0, s63, 94208
    v_mfma_f32_32x32x16_bf16 v[96:111], v[60:63], a[88:91], v[96:111]
    ds_read_b64_tr_b16 v[52:53], v30 offset:512
    ds_read_b64_tr_b16 v[54:55], v30 offset:2560
    buffer_load_dwordx4 v27, s[16:19], s50 offen lds
    s_waitcnt lgkmcnt(8)
    v_mfma_f32_32x32x16_bf16 v[112:127], v[2:5], a[88:91], v[112:127]
    ds_read_b64_tr_b16 v[56:57], v30 offset:768
    ds_read_b64_tr_b16 v[58:59], v30 offset:2816
    v_mfma_f32_32x32x16_bf16 v[80:95], v[6:9], a[92:95], v[80:95]
    ds_read_b64_tr_b16 v[60:61], v30 offset:4352
    ds_read_b64_tr_b16 v[62:63], v30 offset:6400
    s_bfe_u32 s37, s96, 0x80010
    s_cmp_ge_u32 s37, 4
    s_cbranch_scc1 LK_gd47
LK_g46:
    s_waitcnt lgkmcnt(0)
    s_bfe_u32 s37, s96, 0x80010
    s_cmp_ge_u32 s37, 4
    s_cbranch_scc1 LK_gd47
LK_ga48:
    s_cmp_eq_u32 s98, 0
    s_cbranch_scc1 LK_gd47
    s_sub_u32 s98, s98, 1
    s_atomic_umax s96, s[24:25], s58 glc
    s_branch LK_g46
LK_gd47:
    s_add_u32 s53, s57, 1835008
    buffer_load_dwordx4 v[196:199], v32, s[24:27], s53 offen sc1
    s_add_u32 s53, s57, 1851392
    buffer_load_dwordx4 v[200:203], v32, s[24:27], s53 offen sc1
    s_add_u32 s53, s57, 1867776
    buffer_load_dwordx4 v[204:207], v32, s[24:27], s53 offen sc1
    s_add_u32 s53, s57, 1884160
    buffer_load_dwordx4 v[208:211], v32, s[24:27], s53 offen sc1
    s_add_u32 s53, s57, 1900544
    buffer_load_dwordx4 v[212:215], v32, s[24:27], s53 offen sc1
    s_add_u32 s53, s57, 1916928
    buffer_load_dwordx4 v[216:219], v32, s[24:27], s53 offen sc1
    s_add_u32 s53, s57, 1933312
    buffer_load_dwordx4 v[220:223], v32, s[24:27], s53 offen sc1
    s_add_u32 s53, s57, 1949696
    buffer_load_dwordx4 v[224:227], v32, s[24:27], s53 offen sc1
    s_waitcnt lgkmcnt(8)
    v_mfma_f32_32x32x16_bf16 v[96:111], v[40:43], a[92:95], v[96:111]
    ds_read_b64_tr_b16 v[2:3], v30 offset:4608
    ds_read_b64_tr_b16 v[4:5], v30 offset:6656
    v_mfma_f32_32x32x16_bf16 v[112:127], v[44:47], a[92:95], v[112:127]
    ds_read_b64_tr_b16 v[6:7], v30 offset:4864
    ds_read_b64_tr_b16 v[8:9], v30 offset:6912
    s_waitcnt lgkmcnt(8)
    v_mfma_f32_32x32x16_bf16 v[80:95], v[48:51], a[96:99], v[80:95]
    ds_read_b64_tr_b16 v[40:41], v30 offset:8448
    ds_read_b64_tr_b16 v[42:43], v30 offset:10496
    v_mfma_f32_32x32x16_bf16 v[96:111], v[52:55], a[96:99], v[96:111]
    ds_read_b64_tr_b16 v[44:45], v30 offset:8704
    ds_read_b64_tr_b16 v[46:47], v30 offset:10752
    s_waitcnt lgkmcnt(8)
    v_mfma_f32_32x32x16_bf16 v[112:127], v[56:59], a[96:99], v[112:127]
    ds_read_b64_tr_b16 v[48:49], v30 offset:8960
    ds_read_b64_tr_b16 v[50:51], v30 offset:11008
    v_mfma_f32_32x32x16_bf16 v[80:95], v[60:63], a[100:103], v[80:95]
    ds_read_b64_tr_b16 v[52:53], v30 offset:12544
    ds_read_b64_tr_b16 v[54:55], v30 offset:14592
    s_waitcnt lgkmcnt(8)
    v_mfma_f32_32x32x16_bf16 v[96:111], v[2:5], a[100:103], v[96:111]
    ds_read_b64_tr_b16 v[56:57], v30 offset:12800
    ds_read_b64_tr_b16 v[58:59], v30 offset:14848
    v_mfma_f32_32x32x16_bf16 v[112:127], v[6:9], a[100:103], v[112:127]
    ds_read_b64_tr_b16 v[60:61], v30 offset:13056
    ds_read_b64_tr_b16 v[62:63], v30 offset:15104
    s_waitcnt lgkmcnt(8)
    v_mfma_f32_32x32x16_bf16 v[80:95], v[40:43], a[104:107], v[80:95]
    ds_read_b64_tr_b16 v[2:3], v30 offset:40960
    ds_read_b64_tr_b16 v[4:5], v30 offset:43008
    v_mfma_f32_32x32x16_bf16 v[96:111], v[44:47], a[104:107], v[96:111]
    ds_read_b64_tr_b16 v[6:7], v30 offset:45056
    ds_read_b64_tr_b16 v[8:9], v30 offset:47104
    s_waitcnt lgkmcnt(8)
    v_mfma_f32_32x32x16_bf16 v[112:127], v[48:51], a[104:107], v[112:127]
    ds_read_b64_tr_b16 v[40:41], v29 offset:49152
    ds_read_b64_tr_b16 v[42:43], v29 offset:51200
    v_mfma_f32_32x32x16_bf16 v[80:95], v[52:55], a[108:111], v[80:95]
    ds_read_b64_tr_b16 v[44:45], v29 offset:53248
    ds_read_b64_tr_b16 v[46:47], v29 offset:55296
    s_waitcnt vmcnt(8)
    s_barrier
    s_waitcnt lgkmcnt(8)
    v_mfma_f32_32x32x16_bf16 v[96:111], v[56:59], a[108:111], v[96:111]
    ds_read_b64_tr_b16 v[48:49], v29 offset:16640
    ds_read_b64_tr_b16 v[50:51], v29 offset:18688
    v_mfma_f32_32x32x16_bf16 v[112:127], v[60:63], a[108:111], v[112:127]
    ds_read_b64_tr_b16 v[52:53], v29 offset:20736
    ds_read_b64_tr_b16 v[54:55], v29 offset:22784
    s_waitcnt lgkmcnt(8)
    v_mfma_f32_32x32x16_bf16 v[64:79], v[2:5], a[40:43], v[64:79]
    ds_read_b64_tr_b16 v[56:57], v29 offset:24832
    ds_read_b64_tr_b16 v[58:59], v29 offset:26880
    v_mfma_f32_32x32x16_bf16 v[64:79], v[6:9], a[44:47], v[64:79]
    ds_read_b64_tr_b16 v[60:61], v29 offset:28928
    ds_read_b64_tr_b16 v[62:63], v29 offset:30976
    v_mul_f32 v80, v244, v80
    v_mul_f32 v81, v244, v81
    v_mul_f32 v82, v244, v82
    v_mul_f32 v83, v244, v83
    s_waitcnt lgkmcnt(8)
    v_mfma_f32_32x32x16_bf16 v[64:79], v[40:43], a[48:51], v[64:79]
    ds_read_b64_tr_b16 v[2:3], v30 offset:16640
    ds_read_b64_tr_b16 v[4:5], v30 offset:18688
    v_mul_f32 v84, v244, v84
    v_mul_f32 v85, v244, v85
    v_mul_f32 v86, v244, v86
    v_mul_f32 v87, v244, v87
    v_mfma_f32_32x32x16_bf16 v[64:79], v[44:47], a[52:55], v[64:79]
    ds_read_b64_tr_b16 v[6:7], v30 offset:20736
    ds_read_b64_tr_b16 v[8:9], v30 offset:22784
    v_mul_f32 v88, v244, v88
    v_mul_f32 v89, v244, v89
    v_mul_f32 v90, v244, v90
    v_mul_f32 v91, v244, v91
    s_waitcnt vmcnt(7)
    v_mul_f32 v92, v244, v92
    v_mul_f32 v93, v244, v93
    v_mul_f32 v94, v244, v94
    v_mul_f32 v95, v244, v95
    s_waitcnt lgkmcnt(8)
    s_nop 0
    v_mfma_f32_32x32x16_bf16 v[80:95], v[48:51], v[196:199], v[80:95]
    ds_read_b64_tr_b16 v[40:41], v30 offset:24832
    ds_read_b64_tr_b16 v[42:43], v30 offset:26880
    v_mul_f32 v96, v244, v96
    v_mul_f32 v97, v244, v97
    v_mul_f32 v98, v244, v98
    v_mul_f32 v99, v244, v99
    v_mul_f32 v100, v244, v100
    v_mul_f32 v101, v244, v101
    s_waitcnt vmcnt(6)
    v_mfma_f32_32x32x16_bf16 v[80:95], v[52:55], v[200:203], v[80:95]
    ds_read_b64_tr_b16 v[44:45], v30 offset:28928
    ds_read_b64_tr_b16 v[46:47], v30 offset:30976
    v_mul_f32 v102, v244, v102
    v_mul_f32 v103, v244, v103
    v_mul_f32 v104, v244, v104
    v_mul_f32 v105, v244, v105
    v_mul_f32 v106, v244, v106
    v_mul_f32 v107, v244, v107
    s_waitcnt vmcnt(5) lgkmcnt(8)
    v_mfma_f32_32x32x16_bf16 v[80:95], v[56:59], v[204:207], v[80:95]
    ds_read_b64_tr_b16 v[48:49], v29 offset:16896
    ds_read_b64_tr_b16 v[50:51], v29 offset:18944
    v_mul_f32 v108, v244, v108
    v_mul_f32 v109, v244, v109
    v_mul_f32 v110, v244, v110
    v_mul_f32 v111, v244, v111
    v_mul_f32 v112, v244, v112
    v_mul_f32 v113, v244, v113
    s_waitcnt vmcnt(4)
    v_mfma_f32_32x32x16_bf16 v[80:95], v[60:63], v[208:211], v[80:95]
    ds_read_b64_tr_b16 v[52:53], v29 offset:20992
    ds_read_b64_tr_b16 v[54:55], v29 offset:23040
    v_mul_f32 v114, v244, v114
    v_mul_f32 v115, v244, v115
    v_mul_f32 v116, v244, v116
    v_mul_f32 v117, v244, v117
    v_mul_f32 v118, v244, v118
    v_mul_f32 v119, v244, v119
    s_waitcnt vmcnt(3) lgkmcnt(8)
    v_mfma_f32_32x32x16_bf16 v[80:95], v[2:5], v[212:215], v[80:95]
    ds_read_b64_tr_b16 v[56:57], v29 offset:25088
    ds_read_b64_tr_b16 v[58:59], v29 offset:27136
    v_mul_f32 v120, v244, v120
    v_mul_f32 v121, v244, v121
    v_mul_f32 v122, v244, v122
    v_mul_f32 v123, v244, v123
    v_mul_f32 v124, v244, v124
    v_mul_f32 v125, v244, v125
    s_waitcnt vmcnt(2)
    v_mfma_f32_32x32x16_bf16 v[80:95], v[6:9], v[216:219], v[80:95]
    ds_read_b64_tr_b16 v[60:61], v29 offset:29184
    ds_read_b64_tr_b16 v[62:63], v29 offset:31232
    v_mul_f32 v126, v244, v126
    v_mul_f32 v127, v244, v127
    s_waitcnt vmcnt(1) lgkmcnt(8)
    v_mfma_f32_32x32x16_bf16 v[80:95], v[40:43], v[220:223], v[80:95]
    ds_read_b64_tr_b16 v[2:3], v30 offset:16896
    ds_read_b64_tr_b16 v[4:5], v30 offset:18944
    s_waitcnt vmcnt(0)
    v_mfma_f32_32x32x16_bf16 v[80:95], v[44:47], v[224:227], v[80:95]
    ds_read_b64_tr_b16 v[6:7], v30 offset:20992
    ds_read_b64_tr_b16 v[8:9], v30 offset:23040
    s_waitcnt lgkmcnt(8)
    v_mfma_f32_32x32x16_bf16 v[96:111], v[48:51], v[196:199], v[96:111]
    ds_read_b64_tr_b16 v[40:41], v30 offset:25088
    ds_read_b64_tr_b16 v[42:43], v30 offset:27136
    v_mfma_f32_32x32x16_bf16 v[96:111], v[52:55], v[200:203], v[96:111]
    ds_read_b64_tr_b16 v[44:45], v30 offset:29184
    ds_read_b64_tr_b16 v[46:47], v30 offset:31232
    s_nop 2
    v_cvt_pk_bf16_f32 v80, v80, v81
    v_cvt_pk_bf16_f32 v81, v82, v83
    v_cvt_pk_bf16_f32 v82, v84, v85
    v_cvt_pk_bf16_f32 v83, v86, v87
    buffer_store_dwordx4 v[80:83], v34, s[24:27], s4 offen offset:0 sc1
    s_waitcnt lgkmcnt(8)
    v_mfma_f32_32x32x16_bf16 v[96:111], v[56:59], v[204:207], v[96:111]
    ds_read_b64_tr_b16 v[48:49], v29 offset:17152
    ds_read_b64_tr_b16 v[50:51], v29 offset:19200
    v_cvt_pk_bf16_f32 v84, v88, v89
    v_cvt_pk_bf16_f32 v85, v90, v91
    v_cvt_pk_bf16_f32 v86, v92, v93
    v_cvt_pk_bf16_f32 v87, v94, v95
    buffer_store_dwordx4 v[84:87], v34, s[24:27], s4 offen offset:1024 sc1
    v_mfma_f32_32x32x16_bf16 v[96:111], v[60:63], v[208:211], v[96:111]
    ds_read_b64_tr_b16 v[52:53], v29 offset:21248
    ds_read_b64_tr_b16 v[54:55], v29 offset:23296
    s_waitcnt lgkmcnt(8)
    v_mfma_f32_32x32x16_bf16 v[96:111], v[2:5], v[212:215], v[96:111]
    ds_read_b64_tr_b16 v[56:57], v29 offset:25344
    ds_read_b64_tr_b16 v[58:59], v29 offset:27392
    v_mfma_f32_32x32x16_bf16 v[96:111], v[6:9], v[216:219], v[96:111]
    ds_read_b64_tr_b16 v[60:61], v29 offset:29440
    ds_read_b64_tr_b16 v[62:63], v29 offset:31488
    s_waitcnt lgkmcnt(8)
    v_mfma_f32_32x32x16_bf16 v[96:111], v[40:43], v[220:223], v[96:111]
    ds_read_b64_tr_b16 v[2:3], v30 offset:17152
    ds_read_b64_tr_b16 v[4:5], v30 offset:19200
    v_mfma_f32_32x32x16_bf16 v[96:111], v[44:47], v[224:227], v[96:111]
    ds_read_b64_tr_b16 v[6:7], v30 offset:21248
    ds_read_b64_tr_b16 v[8:9], v30 offset:23296
    s_waitcnt lgkmcnt(8)
    v_mfma_f32_32x32x16_bf16 v[112:127], v[48:51], v[196:199], v[112:127]
    ds_read_b64_tr_b16 v[40:41], v30 offset:25344
    ds_read_b64_tr_b16 v[42:43], v30 offset:27392
    v_mfma_f32_32x32x16_bf16 v[112:127], v[52:55], v[200:203], v[112:127]
    ds_read_b64_tr_b16 v[44:45], v30 offset:29440
    ds_read_b64_tr_b16 v[46:47], v30 offset:31488
    s_nop 2
    v_cvt_pk_bf16_f32 v96, v96, v97
    v_cvt_pk_bf16_f32 v97, v98, v99
    v_cvt_pk_bf16_f32 v98, v100, v101
    v_cvt_pk_bf16_f32 v99, v102, v103
    buffer_store_dwordx4 v[96:99], v34, s[24:27], s5 offen offset:0 sc1
    s_waitcnt lgkmcnt(8)
    v_mfma_f32_32x32x16_bf16 v[112:127], v[56:59], v[204:207], v[112:127]
    ds_read_b64_tr_b16 v[48:49], v29 offset:57344
    ds_read_b64_tr_b16 v[50:51], v29 offset:59392
    v_cvt_pk_bf16_f32 v100, v104, v105
    v_cvt_pk_bf16_f32 v101, v106, v107
    v_cvt_pk_bf16_f32 v102, v108, v109
    v_cvt_pk_bf16_f32 v103, v110, v111
    buffer_store_dwordx4 v[100:103], v34, s[24:27], s5 offen offset:1024 sc1
    v_mfma_f32_32x32x16_bf16 v[112:127], v[60:63], v[208:211], v[112:127]
    ds_read_b64_tr_b16 v[52:53], v29 offset:61440
    ds_read_b64_tr_b16 v[54:55], v29 offset:63488
    s_waitcnt lgkmcnt(8)
    v_mfma_f32_32x32x16_bf16 v[112:127], v[2:5], v[212:215], v[112:127]
    ds_read_b64_tr_b16 v[56:57], v30 offset:49152
    ds_read_b64_tr_b16 v[58:59], v30 offset:51200
    v_mfma_f32_32x32x16_bf16 v[112:127], v[6:9], v[216:219], v[112:127]
    ds_read_b64_tr_b16 v[60:61], v30 offset:53248
    ds_read_b64_tr_b16 v[62:63], v30 offset:55296
    s_waitcnt lgkmcnt(8)
    v_mfma_f32_32x32x16_bf16 v[112:127], v[40:43], v[220:223], v[112:127]
    ds_read_b64_tr_b16 v[2:3], v30 offset:57344
    ds_read_b64_tr_b16 v[4:5], v30 offset:59392
    v_mfma_f32_32x32x16_bf16 v[112:127], v[44:47], v[224:227], v[112:127]
    ds_read_b64_tr_b16 v[6:7], v30 offset:61440
    ds_read_b64_tr_b16 v[8:9], v30 offset:63488
    s_waitcnt lgkmcnt(8)
    v_mfma_f32_32x32x16_bf16 v[64:79], v[48:51], a[56:59], v[64:79]
    ds_read_b64_tr_b16 v[40:41], v29 offset:0
    ds_read_b64_tr_b16 v[42:43], v29 offset:2048
    v_mfma_f32_32x32x16_bf16 v[64:79], v[52:55], a[60:63], v[64:79]
    ds_read_b64_tr_b16 v[44:45], v29 offset:4096
    ds_read_b64_tr_b16 v[46:47], v29 offset:6144
    s_nop 2
    v_cvt_pk_bf16_f32 v112, v112, v113
    v_cvt_pk_bf16_f32 v113, v114, v115
    v_cvt_pk_bf16_f32 v114, v116, v117
    v_cvt_pk_bf16_f32 v115, v118, v119
    buffer_store_dwordx4 v[112:115], v34, s[24:27], s6 offen offset:0 sc1
    s_waitcnt lgkmcnt(8)
    v_mfma_f32_32x32x16_bf16 v[64:79], v[56:59], a[64:67], v[64:79]
    ds_read_b64_tr_b16 v[48:49], v29 offset:8192
    ds_read_b64_tr_b16 v[50:51], v29 offset:10240
    v_cvt_pk_bf16_f32 v116, v120, v121
    v_cvt_pk_bf16_f32 v117, v122, v123
    v_cvt_pk_bf16_f32 v118, v124, v125
    v_cvt_pk_bf16_f32 v119, v126, v127
    buffer_store_dwordx4 v[116:119], v34, s[24:27], s6 offen offset:1024 sc1
    v_mfma_f32_32x32x16_bf16 v[64:79], v[60:63], a[68:71], v[64:79]
    ds_read_b64_tr_b16 v[52:53], v29 offset:12288
    ds_read_b64_tr_b16 v[54:55], v29 offset:14336
    s_mov_b32 s60, 0
    s_mul_i32 s54, s48, 24576
    s_add_u32 s54, s54, s62
    s_add_u32 s99, s54, 4096
    s_waitcnt lgkmcnt(8)
    v_mfma_f32_32x32x16_bf16 v[64:79], v[2:5], a[72:75], v[64:79]
    ds_read_b64_tr_b16 v[56:57], v30 offset:0
    ds_read_b64_tr_b16 v[58:59], v30 offset:2048
    v_mfma_f32_32x32x16_bf16 v[64:79], v[6:9], a[76:79], v[64:79]
    ds_read_b64_tr_b16 v[60:61], v30 offset:4096
    ds_read_b64_tr_b16 v[62:63], v30 offset:6144
    s_waitcnt lgkmcnt(8)
    v_mfma_f32_32x32x16_bf16 v[64:79], v[40:43], a[80:83], v[64:79]
    ds_read_b64_tr_b16 v[2:3], v30 offset:8192
    ds_read_b64_tr_b16 v[4:5], v30 offset:10240
    v_mfma_f32_32x32x16_bf16 v[64:79], v[44:47], a[84:87], v[64:79]
    ds_read_b64_tr_b16 v[6:7], v30 offset:12288
    ds_read_b64_tr_b16 v[8:9], v30 offset:14336
    s_waitcnt lgkmcnt(8)
    v_mfma_f32_32x32x16_bf16 v[64:79], v[48:51], a[88:91], v[64:79]
    ds_read_b64_tr_b16 v[40:41], v29 offset:16384
    ds_read_b64_tr_b16 v[42:43], v29 offset:18432
    v_mfma_f32_32x32x16_bf16 v[64:79], v[52:55], a[92:95], v[64:79]
    ds_read_b64_tr_b16 v[44:45], v29 offset:20480
    ds_read_b64_tr_b16 v[46:47], v29 offset:22528
    s_waitcnt lgkmcnt(8)
    v_mfma_f32_32x32x16_bf16 v[64:79], v[56:59], a[96:99], v[64:79]
    ds_read_b64_tr_b16 v[48:49], v29 offset:24576
    ds_read_b64_tr_b16 v[50:51], v29 offset:26624
    v_mfma_f32_32x32x16_bf16 v[64:79], v[60:63], a[100:103], v[64:79]
    ds_read_b64_tr_b16 v[52:53], v29 offset:28672
    ds_read_b64_tr_b16 v[54:55], v29 offset:30720
    s_waitcnt lgkmcnt(8)
    v_mfma_f32_32x32x16_bf16 v[64:79], v[2:5], a[104:107], v[64:79]
    ds_read_b64_tr_b16 v[56:57], v30 offset:16384
    ds_read_b64_tr_b16 v[58:59], v30 offset:18432
    v_mfma_f32_32x32x16_bf16 v[64:79], v[6:9], a[108:111], v[64:79]
    ds_read_b64_tr_b16 v[60:61], v30 offset:20480
    ds_read_b64_tr_b16 v[62:63], v30 offset:22528
    s_waitcnt lgkmcnt(8)
    v_mfma_f32_32x32x16_bf16 v[128:143], v[40:43], v[196:199], 0
    ds_read_b64_tr_b16 v[2:3], v30 offset:24576
    ds_read_b64_tr_b16 v[4:5], v30 offset:26624
    v_mfma_f32_32x32x16_bf16 v[128:143], v[44:47], v[200:203], v[128:143]
    ds_read_b64_tr_b16 v[6:7], v30 offset:28672
    ds_read_b64_tr_b16 v[8:9], v30 offset:30720
    s_waitcnt lgkmcnt(8)
    v_mfma_f32_32x32x16_bf16 v[128:143], v[48:51], v[204:207], v[128:143]
    v_mfma_f32_32x32x16_bf16 v[128:143], v[52:55], v[208:211], v[128:143]
    s_waitcnt lgkmcnt(4)
    v_mfma_f32_32x32x16_bf16 v[128:143], v[56:59], v[212:215], v[128:143]
    v_mfma_f32_32x32x16_bf16 v[128:143], v[60:63], v[216:219], v[128:143]
    s_waitcnt lgkmcnt(0)
    v_mfma_f32_32x32x16_bf16 v[128:143], v[2:5], v[220:223], v[128:143]
    v_mfma_f32_32x32x16_bf16 v[128:143], v[6:9], v[224:227], v[128:143]
    v_pk_add_f32 v[64:65], v[64:65], v[228:229]
    v_pk_add_f32 v[66:67], v[66:67], v[230:231]
    v_pk_add_f32 v[68:69], v[68:69], v[232:233]
    v_pk_add_f32 v[70:71], v[70:71], v[234:235]
    v_pk_add_f32 v[72:73], v[72:73], v[236:237]
    v_pk_add_f32 v[74:75], v[74:75], v[238:239]
    v_pk_add_f32 v[76:77], v[76:77], v[240:241]
    v_pk_add_f32 v[78:79], v[78:79], v[242:243]
    s_waitcnt vmcnt(0)
    s_atomic_add s0, s[24:25], s61
    s_mov_b32 s52, 0
    s_atomic_umax s52, s[24:25], s61 glc
    v_pk_fma_f32 v[64:65], v[64:65], v[244:245], v[128:129] op_sel_hi:[1,0,1]
    v_pk_fma_f32 v[66:67], v[66:67], v[244:245], v[130:131] op_sel_hi:[1,0,1]
    v_pk_fma_f32 v[68:69], v[68:69], v[244:245], v[132:133] op_sel_hi:[1,0,1]
    v_pk_fma_f32 v[70:71], v[70:71], v[244:245], v[134:135] op_sel_hi:[1,0,1]
    v_pk_fma_f32 v[72:73], v[72:73], v[244:245], v[136:137] op_sel_hi:[1,0,1]
    v_pk_fma_f32 v[74:75], v[74:75], v[244:245], v[138:139] op_sel_hi:[1,0,1]
    v_pk_fma_f32 v[76:77], v[76:77], v[244:245], v[140:141] op_sel_hi:[1,0,1]
    v_pk_fma_f32 v[78:79], v[78:79], v[244:245], v[142:143] op_sel_hi:[1,0,1]
    s_bfe_u32 s37, s52, 0x80000
    s_cmp_ge_u32 s37, 4
    s_cbranch_scc1 LK_gd51
LK_g50:
    s_waitcnt lgkmcnt(0)
    s_bfe_u32 s37, s52, 0x80000
    s_cmp_ge_u32 s37, 4
    s_cbranch_scc1 LK_gd51
LK_ga52:
    s_cmp_eq_u32 s98, 0
    s_cbranch_scc1 LK_gd51
    s_sub_u32 s98, s98, 1
    s_atomic_umax s52, s[24:25], s61 glc
    s_branch LK_g50
LK_gd51:
    buffer_load_dwordx4 v[160:163], v34, s[24:27], s54 offen offset:0 sc1
    buffer_load_dwordx4 v[164:167], v34, s[24:27], s54 offen offset:1024 sc1
    buffer_load_dwordx4 v[168:171], v34, s[24:27], s54 offen offset:2048 sc1
    buffer_load_dwordx4 v[172:175], v34, s[24:27], s54 offen offset:3072 sc1
    buffer_load_dwordx4 v[176:179], v34, s[24:27], s99 offen offset:0 sc1
    buffer_load_dwordx4 v[180:183], v34, s[24:27], s99 offen offset:1024 sc1
    s_waitcnt vmcnt(5)
    v_mfma_f32_32x32x16_bf16 v[80:95], v[188:191], v[160:163], v[64:79]
    s_waitcnt vmcnt(4)
    v_mfma_f32_32x32x16_bf16 v[80:95], v[192:195], v[164:167], v[80:95]
    s_waitcnt vmcnt(3)
    v_mfma_f32_32x32x16_bf16 v[80:95], v[188:191], v[168:171], v[80:95]
    s_waitcnt vmcnt(2)
    v_mfma_f32_32x32x16_bf16 v[80:95], v[192:195], v[172:175], v[80:95]
    s_waitcnt vmcnt(1)
    v_mfma_f32_32x32x16_bf16 v[80:95], v[188:191], v[176:179], v[80:95]
    s_waitcnt vmcnt(0)
    v_mfma_f32_32x32x16_bf16 v[80:95], v[192:195], v[180:183], v[80:95]
    s_nop 11
    v_cvt_pk_bf16_f32 v160, v80, v81
    v_cvt_pk_bf16_f32 v161, v82, v83
    ds_write_b64 v18, v[160:161] offset:0
    v_cvt_pk_bf16_f32 v162, v84, v85
    v_cvt_pk_bf16_f32 v163, v86, v87
    ds_write_b64 v18, v[162:163] offset:16
    v_cvt_pk_bf16_f32 v164, v88, v89
    v_cvt_pk_bf16_f32 v165, v90, v91
    ds_write_b64 v18, v[164:165] offset:32
    v_cvt_pk_bf16_f32 v166, v92, v93
    v_cvt_pk_bf16_f32 v167, v94, v95
    ds_write_b64 v18, v[166:167] offset:48
    ds_read_b128 v[168:171], v19 offset:0
    ds_read_b128 v[172:175], v19 offset:1280
    s_waitcnt lgkmcnt(1)
    buffer_store_dwordx4 v[168:171], v20, s[28:31], s40 offen
    s_waitcnt lgkmcnt(0)
    buffer_store_dwordx4 v[172:175], v20, s[28:31], s41 offen
    s_endpgm
LK_i1:
    s_waitcnt lgkmcnt(0)
    s_cmp_ge_u32 s97, 32
    s_cbranch_scc1 LK_id2
    s_cmp_eq_u32 s98, 0
    s_cbranch_scc1 LK_id2
    s_sub_u32 s98, s98, 1
    s_sleep 8
    s_mov_b32 s97, 0
    s_atomic_add s97, s[40:41], 0x0 glc
    s_branch LK_i1
.p2align 6
L_Q:
    s_mov_b32 s0, 1
    s_mov_b32 s1, 0x100
    s_mov_b32 s98, 0x40000
    s_lshl_b32 s99, s44, 6
    s_add_u32 s3, s57, s99
    s_add_u32 s56, s3, 128
    s_load_dwordx16 s[64:79], s[36:37], s3
    s_load_dwordx16 s[80:95], s[36:37], s56
    s_mul_i32 s57, s47, 448
    s_xor_b32 s99, s54, 1
    s_lshl_b32 s99, s99, 8
    s_add_u32 s57, s57, s99
    s_lshl_b32 s99, s44, 7
    s_add_u32 s12, s57, s99
    s_add_u32 s13, s57, 64
    s_and_b32 s57, s57, 0xffffff80
    s_load_dword s14, s[36:37], s12
    s_load_dword s15, s[36:37], s13
    s_add_u32 s53, s52, 1
    s_and_b32 s53, s53, 7
    s_lshl_b32 s50, s45, 10
    s_add_u32 s50, s50, s53
    s_lshl_b32 s50, s50, 7
    s_mul_i32 s51, s53, 229376
    s_add_u32 m0, s63, 16384
    s_nop 0
    buffer_load_dwordx4 v2, s[4:7], s50 offen lds
    s_add_u32 m0, s63, 81920
    s_nop 0
    buffer_load_dwordx4 v6, s[8:11], s51 offen lds
    s_add_u32 m0, s63, 20480
    s_nop 0
    buffer_load_dwordx4 v3, s[4:7], s50 offen lds
    s_add_u32 m0, s63, 86016
    s_nop 0
    buffer_load_dwordx4 v7, s[8:11], s51 offen lds
    s_add_u32 m0, s63, 24576
    s_nop 0
    buffer_load_dwordx4 v4, s[4:7], s50 offen lds
    s_add_u32 m0, s63, 90112
    s_nop 0
    buffer_load_dwordx4 v8, s[8:11], s51 offen lds
    s_add_u32 m0, s63, 28672
    s_nop 0
    buffer_load_dwordx4 v5, s[4:7], s50 offen lds
    s_add_u32 m0, s63, 94208
    s_nop 0
    buffer_load_dwordx4 v9, s[8:11], s51 offen lds
    s_add_u32 s53, s52, 2
    s_and_b32 s53, s53, 7
    s_lshl_b32 s50, s45, 10
    s_add_u32 s50, s50, s53
    s_lshl_b32 s50, s50, 7
    s_mul_i32 s51, s53, 229376
    s_add_u32 m0, s63, 32768
    s_lshl_b32 s2, s56, 9
    s_lshl_b32 s3, s3, 9
    v_lshrrev_b32 v245, 5, v1
    v_and_b32 v246, 31, v1
    v_lshlrev_b32 v35, 2, v246
    v_mov_b32 v254, 0xffff0000
    s_waitcnt lgkmcnt(0)
    s_mov_b32 exec_hi, 0
    v_lshlrev_b32_e64 v176, 16, s64
    v_and_b32 v177, s64, v254
    v_lshlrev_b32_e64 v178, 16, s65
    v_and_b32 v179, s65, v254
    v_lshlrev_b32_e64 v180, 16, s68
    v_and_b32 v181, s68, v254
    v_lshlrev_b32_e64 v182, 16, s69
    v_and_b32 v183, s69, v254
    v_lshlrev_b32_e64 v184, 16, s72
    v_and_b32 v185, s72, v254
    v_lshlrev_b32_e64 v186, 16, s73
    v_and_b32 v187, s73, v254
    v_lshlrev_b32_e64 v188, 16, s76
    v_and_b32 v189, s76, v254
    v_lshlrev_b32_e64 v190, 16, s77
    v_and_b32 v191, s77, v254
    s_mov_b32 exec_hi, -1
    s_mov_b32 exec_lo, 0
    v_lshlrev_b32_e64 v176, 16, s66
    v_and_b32 v177, s66, v254
    v_lshlrev_b32_e64 v178, 16, s67
    v_and_b32 v179, s67, v254
    v_lshlrev_b32_e64 v180, 16, s70
    v_and_b32 v181, s70, v254
    v_lshlrev_b32_e64 v182, 16, s71
    v_and_b32 v183, s71, v254
    v_lshlrev_b32_e64 v184, 16, s74
    v_and_b32 v185, s74, v254
    v_lshlrev_b32_e64 v186, 16, s75
    v_and_b32 v187, s75, v254
    v_lshlrev_b32_e64 v188, 16, s78
    v_and_b32 v189, s78, v254
    v_lshlrev_b32_e64 v190, 16, s79
    v_and_b32 v191, s79, v254
    s_mov_b64 exec, -1
    s_mov_b32 exec_hi, 0
    v_lshlrev_b32_e64 v192, 16, s80
    v_and_b32 v193, s80, v254
    v_lshlrev_b32_e64 v194, 16, s81
    v_and_b32 v195, s81, v254
    v_lshlrev_b32_e64 v196, 16, s84
    v_and_b32 v197, s84, v254
    v_lshlrev_b32_e64 v198, 16, s85
    v_and_b32 v199, s85, v254
    v_lshlrev_b32_e64 v200, 16, s88
    v_and_b32 v201, s88, v254
    v_lshlrev_b32_e64 v202, 16, s89
    v_and_b32 v203, s89, v254
    v_lshlrev_b32_e64 v204, 16, s92
    v_and_b32 v205, s92, v254
    v_lshlrev_b32_e64 v206, 16, s93
    v_and_b32 v207, s93, v254
    s_mov_b32 exec_hi, -1
    s_mov_b32 exec_lo, 0
    v_lshlrev_b32_e64 v192, 16, s82
    v_and_b32 v193, s82, v254
    v_lshlrev_b32_e64 v194, 16, s83
    v_and_b32 v195, s83, v254
    v_lshlrev_b32_e64 v196, 16, s86
    v_and_b32 v197, s86, v254
    v_lshlrev_b32_e64 v198, 16, s87
    v_and_b32 v199, s87, v254
    v_lshlrev_b32_e64 v200, 16, s90
    v_and_b32 v201, s90, v254
    v_lshlrev_b32_e64 v202, 16, s91
    v_and_b32 v203, s91, v254
    v_lshlrev_b32_e64 v204, 16, s94
    v_and_b32 v205, s94, v254
    v_lshlrev_b32_e64 v206, 16, s95
    v_and_b32 v207, s95, v254
    s_mov_b64 exec, -1
    s_load_dwordx16 s[64:79], s[36:37], s12
    s_load_dwordx16 s[80:95], s[36:37], s13
    v_bfe_u32 v240, v246, 1, 3
    v_xor_b32 v240, v240, v245
    v_lshlrev_b32 v240, 4, v240
    v_lshl_add_u32 v240, v246, 7, v240
    v_add_u32 v14, s55, v240
    v_xor_b32 v18, 0x1000, v14
    v_xor_b32 v15, 32, v14
    v_xor_b32 v16, 64, v14
    v_xor_b32 v17, 96, v14
    v_xor_b32 v19, 32, v18
    v_xor_b32 v20, 64, v18
    v_xor_b32 v21, 96, v18
    v_bfe_u32 v240, v1, 2, 2
    v_lshlrev_b32 v244, 6, v240
    v_and_b32 v240, 1, v241
    v_lshl_add_u32 v244, v240, 5, v244
    v_lshrrev_b32 v240, 1, v243
    v_add_u32 v244, v244, v240
    v_lshl_add_u32 v240, v245, 11, v244
    s_lshl_b32 s99, s44, 8
    s_add_u32 s99, s99, 0x10000
    v_add_u32 v22, s99, v240
    s_lshl_b32 s99, s44, 1
    s_add_u32 s99, s99, s54
    s_lshl_b32 s99, s99, 8
    v_add_u32 v23, s99, v240
    v_add_u32 v24, 0x10000, v23
    s_add_u32 s99, s54, 1
    s_lshl_b32 s99, s99, 8
    v_add_u32 v25, s99, v240
    v_add_u32 v26, 0x10000, v25
    v_lshl_add_u32 v29, v245, 10, v244
    v_add_u32 v30, 0x10000, v29
    v_add_u32 v31, 0x20000, v29
    v_mul_u32_u24 v10, 3584, v242
    v_lshl_add_u32 v244, v241, 6, v243
    v_add3_u32 v10, v10, v244, s57
    v_add_u32 v11, 14336, v10
    v_add_u32 v12, 28672, v10
    v_add_u32 v13, 43008, v10
    v_add_u32 v240, s48, v241
    v_and_b32 v240, 3, v240
    v_lshl_add_u32 v244, v240, 6, v243
    v_bfe_u32 v240, v1, 2, 2
    v_lshl_add_u32 v240, v240, 10, v244
    s_lshl_b32 s99, s49, 8
    s_add_u32 s99, s99, s55
    v_add_u32 v27, s99, v240
    s_lshr_b32 s99, s45, 2
    s_mul_i32 s99, s99, 2424832
    s_and_b32 s56, s45, 3
    s_lshl_b32 s56, s56, 2
    s_add_u32 s56, s56, s42
    s_lshl_b32 s56, s56, 10
    s_add_u32 s99, s99, s56
    s_add_u32 s99, s99, 0x10000
    v_add_u32 v32, s99, v34
    v_xor_b32 v33, 0x400, v32
    s_mul_i32 s56, s48, 458752
    s_mul_i32 s99, s54, 327680
    s_add_u32 s100, s56, s99
    s_sub_u32 s101, s56, s99
    s_mul_i32 s99, s54, 98304
    s_add_u32 s14, s56, s99
    s_sub_u32 s56, s56, s99
    s_lshl_b32 s57, s48, 17
    s_lshl_b32 s99, s45, 1
    s_add_u32 s15, s99, s43
    s_lshl_b32 s58, s15, 2
    s_lshr_b32 s97, s46, 2
    s_add_u32 s58, s58, s97
    s_lshl_b32 s59, s47, 1
    s_add_u32 s59, s59, s44
    s_lshl_b32 s59, s59, 2
    s_lshl_b32 s62, s45, 2
    s_add_u32 s62, s62, s49
    s_lshl_b32 s61, s62, 2
    s_add_u32 s61, s61, s42
    s_lshl_b32 s62, s62, 4
    s_add_u32 s62, s62, s42
    s_mul_i32 s62, s62, 6144
    s_add_u32 s62, s62, 0xa00000
    s_lshl_b32 s58, s58, 8
    s_add_u32 s58, s58, 0x1200000
    s_lshl_b32 s59, s59, 8
    s_add_u32 s59, s59, 0x121b000
    s_lshl_b32 s61, s61, 8
    s_add_u32 s61, s61, 0x120b000
    s_lshl_b32 s15, s15, 8
    s_add_u32 s15, s15, 0x1209000
    s_waitcnt lgkmcnt(0)
    s_mov_b32 exec_hi, 0
    v_lshlrev_b32_e64 v208, 16, s64
    v_and_b32 v209, s64, v254
    v_lshlrev_b32_e64 v210, 16, s65
    v_and_b32 v211, s65, v254
    v_lshlrev_b32_e64 v212, 16, s68
    v_and_b32 v213, s68, v254
    v_lshlrev_b32_e64 v214, 16, s69
    v_and_b32 v215, s69, v254
    v_lshlrev_b32_e64 v216, 16, s72
    v_and_b32 v217, s72, v254
    v_lshlrev_b32_e64 v218, 16, s73
    v_and_b32 v219, s73, v254
    v_lshlrev_b32_e64 v220, 16, s76
    v_and_b32 v221, s76, v254
    v_lshlrev_b32_e64 v222, 16, s77
    v_and_b32 v223, s77, v254
    s_mov_b32 exec_hi, -1
    s_mov_b32 exec_lo, 0
    v_lshlrev_b32_e64 v208, 16, s66
    v_and_b32 v209, s66, v254
    v_lshlrev_b32_e64 v210, 16, s67
    v_and_b32 v211, s67, v254
    v_lshlrev_b32_e64 v212, 16, s70
    v_and_b32 v213, s70, v254
    v_lshlrev_b32_e64 v214, 16, s71
    v_and_b32 v215, s71, v254
    v_lshlrev_b32_e64 v216, 16, s74
    v_and_b32 v217, s74, v254
    v_lshlrev_b32_e64 v218, 16, s75
    v_and_b32 v219, s75, v254
    v_lshlrev_b32_e64 v220, 16, s78
    v_and_b32 v221, s78, v254
    v_lshlrev_b32_e64 v222, 16, s79
    v_and_b32 v223, s79, v254
    s_mov_b64 exec, -1
    s_mov_b32 exec_hi, 0
    v_lshlrev_b32_e64 v224, 16, s80
    v_and_b32 v225, s80, v254
    v_lshlrev_b32_e64 v226, 16, s81
    v_and_b32 v227, s81, v254
    v_lshlrev_b32_e64 v228, 16, s84
    v_and_b32 v229, s84, v254
    v_lshlrev_b32_e64 v230, 16, s85
    v_and_b32 v231, s85, v254
    v_lshlrev_b32_e64 v232, 16, s88
    v_and_b32 v233, s88, v254
    v_lshlrev_b32_e64 v234, 16, s89
    v_and_b32 v235, s89, v254
    v_lshlrev_b32_e64 v236, 16, s92
    v_and_b32 v237, s92, v254
    v_lshlrev_b32_e64 v238, 16, s93
    v_and_b32 v239, s93, v254
    s_mov_b32 exec_hi, -1
    s_mov_b32 exec_lo, 0
    v_lshlrev_b32_e64 v224, 16, s82
    v_and_b32 v225, s82, v254
    v_lshlrev_b32_e64 v226, 16, s83
    v_and_b32 v227, s83, v254
    v_lshlrev_b32_e64 v228, 16, s86
    v_and_b32 v229, s86, v254
    v_lshlrev_b32_e64 v230, 16, s87
    v_and_b32 v231, s87, v254
    v_lshlrev_b32_e64 v232, 16, s90
    v_and_b32 v233, s90, v254
    v_lshlrev_b32_e64 v234, 16, s91
    v_and_b32 v235, s91, v254
    v_lshlrev_b32_e64 v236, 16, s94
    v_and_b32 v237, s94, v254
    v_lshlrev_b32_e64 v238, 16, s95
    v_and_b32 v239, s95, v254
    s_mov_b64 exec, -1
    s_lshl_b32 s12, s12, 9
    s_lshl_b32 s13, s13, 9
    v_mov_b32 v246, s28
    v_mov_b32 v247, s29
    v_writelane_b32 v246, s20, 4
    v_writelane_b32 v247, s21, 4
    v_writelane_b32 v246, s16, 8
    v_writelane_b32 v247, s17, 8
    v_writelane_b32 v246, s38, 12
    v_writelane_b32 v247, s39, 12
    global_load_dword v253, v[246:247], off
    v_lshlrev_b32 v246, 21, v1
    buffer_load_dword v253, v246, s[24:27], 0 offen sc1
    s_waitcnt vmcnt(10)
    s_barrier
    ds_read_b128 a[0:3], v14 offset:0
    ds_read_b128 a[4:7], v18 offset:0
    ds_read_b64_tr_b16 v[40:41], v22 offset:0
    ds_read_b64_tr_b16 v[42:43], v22 offset:1024
    ds_read_b64_tr_b16 v[44:45], v22 offset:512
    ds_read_b64_tr_b16 v[46:47], v22 offset:1536
    buffer_load_dwordx4 v2, s[4:7], s50 offen lds
    s_add_u32 m0, s63, 98304
    s_nop 0
    buffer_load_dwordx4 v6, s[8:11], s51 offen lds
    s_add_u32 m0, s63, 36864
    ds_read_b128 a[8:11], v15 offset:0
    ds_read_b128 a[12:15], v19 offset:0
    ds_read_b64_tr_b16 v[48:49], v22 offset:4096
    ds_read_b64_tr_b16 v[50:51], v22 offset:5120
    ds_read_b64_tr_b16 v[52:53], v22 offset:4608
    ds_read_b64_tr_b16 v[54:55], v22 offset:5632
    buffer_load_dwordx4 v3, s[4:7], s50 offen lds
    s_add_u32 m0, s63, 102400
    s_nop 0
    buffer_load_dwordx4 v7, s[8:11], s51 offen lds
    s_add_u32 m0, s63, 40960
    s_waitcnt lgkmcnt(6)
    v_mfma_f32_32x32x16_bf16 v[64:79], v[40:43], a[0:3], v[176:191]
    ds_read_b128 a[16:19], v16 offset:0
    ds_read_b128 a[20:23], v20 offset:0
    v_mfma_f32_32x32x16_bf16 v[80:95], v[40:43], a[4:7], v[176:191]
    ds_read_b64_tr_b16 v[56:57], v22 offset:8192
    ds_read_b64_tr_b16 v[58:59], v22 offset:9216
    buffer_load_dwordx4 v4, s[4:7], s50 offen lds
    s_add_u32 m0, s63, 106496
    v_mfma_f32_32x32x16_bf16 v[96:111], v[44:47], a[0:3], v[192:207]
    ds_read_b64_tr_b16 v[60:61], v22 offset:8704
    ds_read_b64_tr_b16 v[62:63], v22 offset:9728
    v_mfma_f32_32x32x16_bf16 v[112:127], v[44:47], a[4:7], v[192:207]
    buffer_load_dwordx4 v8, s[8:11], s51 offen lds
    s_add_u32 m0, s63, 45056
    s_waitcnt lgkmcnt(6)
    v_mfma_f32_32x32x16_bf16 v[64:79], v[48:51], a[8:11], v[64:79]
    ds_read_b128 a[24:27], v17 offset:0
    ds_read_b128 a[28:31], v21 offset:0
    buffer_load_dwordx4 v5, s[4:7], s50 offen lds
    s_add_u32 m0, s63, 110592
    v_mfma_f32_32x32x16_bf16 v[80:95], v[48:51], a[12:15], v[80:95]
    ds_read_b64_tr_b16 v[40:41], v22 offset:12288
    ds_read_b64_tr_b16 v[42:43], v22 offset:13312
    v_mfma_f32_32x32x16_bf16 v[96:111], v[52:55], a[8:11], v[96:111]
    ds_read_b64_tr_b16 v[44:45], v22 offset:12800
    ds_read_b64_tr_b16 v[46:47], v22 offset:13824
    buffer_load_dwordx4 v9, s[8:11], s51 offen lds
    v_mfma_f32_32x32x16_bf16 v[112:127], v[52:55], a[12:15], v[112:127]
    s_waitcnt vmcnt(10)
    s_barrier
    s_and_b32 s37, s45, 7
    s_lshl_b32 s37, s37, 2
    s_or_b32 s37, s37, s49
    s_cmp_lg_u32 s37, 1
    s_cbranch_scc1 LQ_noinit2
    s_atomic_add s0, s[40:41], 0x0
LQ_noinit2:
    s_waitcnt lgkmcnt(6)
    v_mfma_f32_32x32x16_bf16 v[64:79], v[56:59], a[16:19], v[64:79]
    ds_read_b128 a[32:35], v14 offset:16384
    ds_read_b128 a[36:39], v18 offset:16384
    s_add_u32 s53, s52, 3
    s_and_b32 s53, s53, 7
    s_lshl_b32 s50, s45, 10
    s_add_u32 s50, s50, s53
    s_lshl_b32 s50, s50, 7
    s_mul_i32 s51, s53, 229376
    s_add_u32 m0, s63, 49152
    s_nop 0
    buffer_load_dwordx4 v2, s[4:7], s50 offen lds
    s_add_u32 m0, s63, 114688
    v_mfma_f32_32x32x16_bf16 v[80:95], v[56:59], a[20:23], v[80:95]
    ds_read_b64_tr_b16 v[48:49], v22 offset:16384
    ds_read_b64_tr_b16 v[50:51], v22 offset:17408
    buffer_load_dwordx4 v6, s[8:11], s51 offen lds
    s_add_u32 m0, s63, 53248
    v_mfma_f32_32x32x16_bf16 v[96:111], v[60:63], a[16:19], v[96:111]
    ds_read_b64_tr_b16 v[52:53], v22 offset:16896
    ds_read_b64_tr_b16 v[54:55], v22 offset:17920
    buffer_load_dwordx4 v3, s[4:7], s50 offen lds
    s_add_u32 m0, s63, 118784
    v_lshrrev_b32 v240, 5, v1
    v_and_b32 v241, 31, v1
    v_mfma_f32_32x32x16_bf16 v[112:127], v[60:63], a[20:23], v[112:127]
    v_lshlrev_b32 v240, 2, v240
    v_sub_u32 v240, v241, v240
    v_and_b32 v242, 1, v240
    s_waitcnt lgkmcnt(6)
    v_mfma_f32_32x32x16_bf16 v[64:79], v[40:43], a[24:27], v[64:79]
    ds_read_b128 a[40:43], v15 offset:16384
    ds_read_b128 a[44:47], v19 offset:16384
    buffer_load_dwordx4 v7, s[8:11], s51 offen lds
    s_add_u32 m0, s63, 57344
    v_mfma_f32_32x32x16_bf16 v[80:95], v[40:43], a[28:31], v[80:95]
    ds_read_b64_tr_b16 v[56:57], v22 offset:20480
    ds_read_b64_tr_b16 v[58:59], v22 offset:21504
    buffer_load_dwordx4 v4, s[4:7], s50 offen lds
    s_add_u32 m0, s63, 122880
    v_mfma_f32_32x32x16_bf16 v[96:111], v[44:47], a[24:27], v[96:111]
    ds_read_b64_tr_b16 v[60:61], v22 offset:20992
    ds_read_b64_tr_b16 v[62:63], v22 offset:22016
    v_lshlrev_b32 v242, 4, v242
    v_mov_b32 v243, 0x3f80
    v_lshlrev_b32 v242, v242, v243
    v_mfma_f32_32x32x16_bf16 v[112:127], v[44:47], a[28:31], v[112:127]
    buffer_load_dwordx4 v8, s[8:11], s51 offen lds
    s_add_u32 m0, s63, 61440
    s_waitcnt lgkmcnt(6)
    v_mfma_f32_32x32x16_bf16 v[64:79], v[48:51], a[32:35], v[64:79]
    ds_read_b128 a[48:51], v16 offset:16384
    ds_read_b128 a[52:55], v20 offset:16384
    buffer_load_dwordx4 v5, s[4:7], s50 offen lds
    s_add_u32 m0, s63, 126976
    v_mfma_f32_32x32x16_bf16 v[80:95], v[48:51], a[36:39], v[80:95]
    ds_read_b64_tr_b16 v[40:41], v22 offset:24576
    ds_read_b64_tr_b16 v[42:43], v22 offset:25600
    v_ashrrev_i32 v240, 1, v240
    v_cmp_eq_u32 vcc, 0, v240
    v_cmp_eq_u32 s[32:33], 1, v240
    v_mfma_f32_32x32x16_bf16 v[96:111], v[52:55], a[32:35], v[96:111]
    ds_read_b64_tr_b16 v[44:45], v22 offset:25088
    ds_read_b64_tr_b16 v[46:47], v22 offset:26112
    buffer_load_dwordx4 v9, s[8:11], s51 offen lds
    v_mfma_f32_32x32x16_bf16 v[112:127], v[52:55], a[36:39], v[112:127]
    v_cmp_eq_u32 s[34:35], 4, v240
    v_cndmask_b32 v188, 0, v242, vcc
    v_cmp_eq_u32 vcc, 5, v240
    s_waitcnt lgkmcnt(6)
    v_mfma_f32_32x32x16_bf16 v[64:79], v[56:59], a[40:43], v[64:79]
    ds_read_b128 a[56:59], v17 offset:16384
    ds_read_b128 a[60:63], v21 offset:16384
    v_cndmask_b32 v189, 0, v242, s[32:33]
    v_cmp_eq_u32 s[32:33], 8, v240
    v_cndmask_b32 v190, 0, v242, s[34:35]
    v_mfma_f32_32x32x16_bf16 v[80:95], v[56:59], a[44:47], v[80:95]
    ds_read_b64_tr_b16 v[48:49], v22 offset:28672
    ds_read_b64_tr_b16 v[50:51], v22 offset:29696
    v_cmp_eq_u32 s[34:35], 9, v240
    v_cndmask_b32 v191, 0, v242, vcc
    v_cmp_eq_u32 vcc, 12, v240
    v_mfma_f32_32x32x16_bf16 v[96:111], v[60:63], a[40:43], v[96:111]
    ds_read_b64_tr_b16 v[52:53], v22 offset:29184
    ds_read_b64_tr_b16 v[54:55], v22 offset:30208
    v_cndmask_b32 v192, 0, v242, s[32:33]
    v_cmp_eq_u32 s[32:33], 13, v240
    v_cndmask_b32 v193, 0, v242, s[34:35]
    v_mfma_f32_32x32x16_bf16 v[112:127], v[60:63], a[44:47], v[112:127]
    v_cndmask_b32 v194, 0, v242, vcc
    v_cndmask_b32 v195, 0, v242, s[32:33]
    s_waitcnt vmcnt(8)
    s_barrier
    s_waitcnt lgkmcnt(6)
    v_mfma_f32_32x32x16_bf16 v[64:79], v[40:43], a[48:51], v[64:79]
    ds_read_b128 a[64:67], v14 offset:32768
    ds_read_b128 a[68:71], v18 offset:32768
    s_add_u32 s53, s52, 4
    s_and_b32 s53, s53, 7
    s_lshl_b32 s50, s45, 10
    s_add_u32 s50, s50, s53
    s_lshl_b32 s50, s50, 7
    s_mul_i32 s51, s53, 229376
    s_add_u32 m0, s63, 0
    s_nop 0
    buffer_load_dwordx4 v2, s[4:7], s50 offen lds
    s_add_u32 m0, s63, 65536
    v_mfma_f32_32x32x16_bf16 v[80:95], v[40:43], a[52:55], v[80:95]
    ds_read_b64_tr_b16 v[56:57], v22 offset:32768
    ds_read_b64_tr_b16 v[58:59], v22 offset:33792
    buffer_load_dwordx4 v6, s[8:11], s51 offen lds
    s_add_u32 m0, s63, 4096
    v_mfma_f32_32x32x16_bf16 v[96:111], v[44:47], a[48:51], v[96:111]
    ds_read_b64_tr_b16 v[60:61], v22 offset:33280
    ds_read_b64_tr_b16 v[62:63], v22 offset:34304
    buffer_load_dwordx4 v3, s[4:7], s50 offen lds
    s_add_u32 m0, s63, 69632
    v_mfma_f32_32x32x16_bf16 v[112:127], v[44:47], a[52:55], v[112:127]
    s_waitcnt lgkmcnt(6)
    v_mfma_f32_32x32x16_bf16 v[64:79], v[48:51], a[56:59], v[64:79]
    ds_read_b128 a[72:75], v15 offset:32768
    ds_read_b128 a[76:79], v19 offset:32768
    buffer_load_dwordx4 v7, s[8:11], s51 offen lds
    s_add_u32 m0, s63, 8192
    v_mfma_f32_32x32x16_bf16 v[80:95], v[48:51], a[60:63], v[80:95]
    ds_read_b64_tr_b16 v[40:41], v22 offset:36864
    ds_read_b64_tr_b16 v[42:43], v22 offset:37888
    buffer_load_dwordx4 v4, s[4:7], s50 offen lds
    s_add_u32 m0, s63, 73728
    v_mfma_f32_32x32x16_bf16 v[96:111], v[52:55], a[56:59], v[96:111]
    ds_read_b64_tr_b16 v[44:45], v22 offset:37376
    ds_read_b64_tr_b16 v[46:47], v22 offset:38400
    v_mfma_f32_32x32x16_bf16 v[112:127], v[52:55], a[60:63], v[112:127]
    buffer_load_dwordx4 v8, s[8:11], s51 offen lds
    s_add_u32 m0, s63, 12288
    s_waitcnt lgkmcnt(6)
    v_mfma_f32_32x32x16_bf16 v[64:79], v[56:59], a[64:67], v[64:79]
    ds_read_b128 a[80:83], v16 offset:32768
    ds_read_b128 a[84:87], v20 offset:32768
    buffer_load_dwordx4 v5, s[4:7], s50 offen lds
    s_add_u32 m0, s63, 77824
    v_mfma_f32_32x32x16_bf16 v[80:95], v[56:59], a[68:71], v[80:95]
    ds_read_b64_tr_b16 v[48:49], v22 offset:40960
    ds_read_b64_tr_b16 v[50:51], v22 offset:41984
    v_mfma_f32_32x32x16_bf16 v[96:111], v[60:63], a[64:67], v[96:111]
    ds_read_b64_tr_b16 v[52:53], v22 offset:41472
    ds_read_b64_tr_b16 v[54:55], v22 offset:42496
    buffer_load_dwordx4 v9, s[8:11], s51 offen lds
    v_mfma_f32_32x32x16_bf16 v[112:127], v[60:63], a[68:71], v[112:127]
    s_waitcnt lgkmcnt(6)
    v_mfma_f32_32x32x16_bf16 v[64:79], v[40:43], a[72:75], v[64:79]
    ds_read_b128 a[88:91], v17 offset:32768
    ds_read_b128 a[92:95], v21 offset:32768
    v_mfma_f32_32x32x16_bf16 v[80:95], v[40:43], a[76:79], v[80:95]
    ds_read_b64_tr_b16 v[56:57], v22 offset:45056
    ds_read_b64_tr_b16 v[58:59], v22 offset:46080
    v_mfma_f32_32x32x16_bf16 v[96:111], v[44:47], a[72:75], v[96:111]
    ds_read_b64_tr_b16 v[60:61], v22 offset:45568
    ds_read_b64_tr_b16 v[62:63], v22 offset:46592
    v_mfma_f32_32x32x16_bf16 v[112:127], v[44:47], a[76:79], v[112:127]
    s_waitcnt vmcnt(8)
    s_barrier
    s_waitcnt lgkmcnt(6)
    v_mfma_f32_32x32x16_bf16 v[64:79], v[48:51], a[80:83], v[64:79]
    ds_read_b128 a[96:99], v14 offset:49152
    ds_read_b128 a[100:103], v18 offset:49152
    s_add_u32 s53, s52, 5
    s_and_b32 s53, s53, 7
    s_lshl_b32 s50, s45, 10
    s_add_u32 s50, s50, s53
    s_lshl_b32 s50, s50, 7
    s_mul_i32 s51, s53, 229376
    s_add_u32 m0, s63, 16384
    s_nop 0
    buffer_load_dwordx4 v2, s[4:7], s50 offen lds
    s_add_u32 m0, s63, 81920
    v_mfma_f32_32x32x16_bf16 v[80:95], v[48:51], a[84:87], v[80:95]
    ds_read_b64_tr_b16 v[40:41], v22 offset:49152
    ds_read_b64_tr_b16 v[42:43], v22 offset:50176
    buffer_load_dwordx4 v6, s[8:11], s51 offen lds
    s_add_u32 m0, s63, 20480
    v_mfma_f32_32x32x16_bf16 v[96:111], v[52:55], a[80:83], v[96:111]
    ds_read_b64_tr_b16 v[44:45], v22 offset:49664
    ds_read_b64_tr_b16 v[46:47], v22 offset:50688
    buffer_load_dwordx4 v3, s[4:7], s50 offen lds
    s_add_u32 m0, s63, 86016
    v_mfma_f32_32x32x16_bf16 v[112:127], v[52:55], a[84:87], v[112:127]
    s_waitcnt lgkmcnt(6)
    v_mfma_f32_32x32x16_bf16 v[64:79], v[56:59], a[88:91], v[64:79]
    ds_read_b128 a[104:107], v15 offset:49152
    ds_read_b128 a[108:111], v19 offset:49152
    buffer_load_dwordx4 v7, s[8:11], s51 offen lds
    s_add_u32 m0, s63, 24576
    v_mfma_f32_32x32x16_bf16 v[80:95], v[56:59], a[92:95], v[80:95]
    ds_read_b64_tr_b16 v[48:49], v22 offset:53248
    ds_read_b64_tr_b16 v[50:51], v22 offset:54272
    buffer_load_dwordx4 v4, s[4:7], s50 offen lds
    s_add_u32 m0, s63, 90112
    v_mfma_f32_32x32x16_bf16 v[96:111], v[60:63], a[88:91], v[96:111]
    ds_read_b64_tr_b16 v[52:53], v22 offset:53760
    ds_read_b64_tr_b16 v[54:55], v22 offset:54784
    v_mfma_f32_32x32x16_bf16 v[112:127], v[60:63], a[92:95], v[112:127]
    buffer_load_dwordx4 v8, s[8:11], s51 offen lds
    s_add_u32 m0, s63, 28672
    s_waitcnt lgkmcnt(6)
    v_mfma_f32_32x32x16_bf16 v[64:79], v[40:43], a[96:99], v[64:79]
    ds_read_b128 a[112:115], v16 offset:49152
    ds_read_b128 a[116:119], v20 offset:49152
    buffer_load_dwordx4 v5, s[4:7], s50 offen lds
    s_add_u32 m0, s63, 94208
    v_mfma_f32_32x32x16_bf16 v[80:95], v[40:43], a[100:103], v[80:95]
    ds_read_b64_tr_b16 v[56:57], v22 offset:57344
    ds_read_b64_tr_b16 v[58:59], v22 offset:58368
    v_mfma_f32_32x32x16_bf16 v[96:111], v[44:47], a[96:99], v[96:111]
    ds_read_b64_tr_b16 v[60:61], v22 offset:57856
    ds_read_b64_tr_b16 v[62:63], v22 offset:58880
    buffer_load_dwordx4 v9, s[8:11], s51 offen lds
    v_mfma_f32_32x32x16_bf16 v[112:127], v[44:47], a[100:103], v[112:127]
    s_waitcnt lgkmcnt(6)
    v_mfma_f32_32x32x16_bf16 v[64:79], v[48:51], a[104:107], v[64:79]
    ds_read_b128 a[120:123], v17 offset:49152
    ds_read_b128 a[124:127], v21 offset:49152
    v_mfma_f32_32x32x16_bf16 v[80:95], v[48:51], a[108:111], v[80:95]
    ds_read_b64_tr_b16 v[40:41], v22 offset:61440
    ds_read_b64_tr_b16 v[42:43], v22 offset:62464
    v_mfma_f32_32x32x16_bf16 v[96:111], v[52:55], a[104:107], v[96:111]
    ds_read_b64_tr_b16 v[44:45], v22 offset:61952
    ds_read_b64_tr_b16 v[46:47], v22 offset:62976
    v_mfma_f32_32x32x16_bf16 v[112:127], v[52:55], a[108:111], v[112:127]
    s_waitcnt vmcnt(8)
    s_barrier
    s_waitcnt lgkmcnt(6)
    v_mfma_f32_32x32x16_bf16 v[64:79], v[56:59], a[112:115], v[64:79]
    ds_read_b128 a[128:131], v14 offset:0
    ds_read_b128 a[132:135], v18 offset:0
    s_add_u32 s53, s52, 6
    s_and_b32 s53, s53, 7
    s_lshl_b32 s50, s45, 10
    s_add_u32 s50, s50, s53
    s_lshl_b32 s50, s50, 7
    s_mul_i32 s51, s53, 229376
    s_add_u32 m0, s63, 32768
    s_nop 0
    buffer_load_dwordx4 v2, s[4:7], s50 offen lds
    s_add_u32 m0, s63, 98304
    v_mfma_f32_32x32x16_bf16 v[80:95], v[56:59], a[116:119], v[80:95]
    ds_read_b64_tr_b16 v[48:49], v22 offset:0
    ds_read_b64_tr_b16 v[50:51], v22 offset:1024
    buffer_load_dwordx4 v6, s[8:11], s51 offen lds
    s_add_u32 m0, s63, 36864
    v_mfma_f32_32x32x16_bf16 v[96:111], v[60:63], a[112:115], v[96:111]
    ds_read_b64_tr_b16 v[52:53], v22 offset:512
    ds_read_b64_tr_b16 v[54:55], v22 offset:1536
    buffer_load_dwordx4 v3, s[4:7], s50 offen lds
    s_add_u32 m0, s63, 102400
    v_mfma_f32_32x32x16_bf16 v[112:127], v[60:63], a[116:119], v[112:127]
    s_waitcnt lgkmcnt(6)
    v_mfma_f32_32x32x16_bf16 v[64:79], v[40:43], a[120:123], v[64:79]
    ds_read_b128 a[136:139], v15 offset:0
    ds_read_b128 a[140:143], v19 offset:0
    buffer_load_dwordx4 v7, s[8:11], s51 offen lds
    s_add_u32 m0, s63, 40960
    v_mfma_f32_32x32x16_bf16 v[80:95], v[40:43], a[124:127], v[80:95]
    ds_read_b64_tr_b16 v[56:57], v22 offset:4096
    ds_read_b64_tr_b16 v[58:59], v22 offset:5120
    buffer_load_dwordx4 v4, s[4:7], s50 offen lds
    s_add_u32 m0, s63, 106496
    v_mfma_f32_32x32x16_bf16 v[96:111], v[44:47], a[120:123], v[96:111]
    ds_read_b64_tr_b16 v[60:61], v22 offset:4608
    ds_read_b64_tr_b16 v[62:63], v22 offset:5632
    v_mfma_f32_32x32x16_bf16 v[112:127], v[44:47], a[124:127], v[112:127]
    buffer_load_dwordx4 v8, s[8:11], s51 offen lds
    s_add_u32 m0, s63, 45056
    s_waitcnt lgkmcnt(6)
    v_mfma_f32_32x32x16_bf16 v[64:79], v[48:51], a[128:131], v[64:79]
    ds_read_b128 a[144:147], v16 offset:0
    ds_read_b128 a[148:151], v20 offset:0
    buffer_load_dwordx4 v5, s[4:7], s50 offen lds
    s_add_u32 m0, s63, 110592
    v_mfma_f32_32x32x16_bf16 v[80:95], v[48:51], a[132:135], v[80:95]
    ds_read_b64_tr_b16 v[40:41], v22 offset:8192
    ds_read_b64_tr_b16 v[42:43], v22 offset:9216
    v_mfma_f32_32x32x16_bf16 v[96:111], v[52:55], a[128:131], v[96:111]
    ds_read_b64_tr_b16 v[44:45], v22 offset:8704
    ds_read_b64_tr_b16 v[46:47], v22 offset:9728
    buffer_load_dwordx4 v9, s[8:11], s51 offen lds
    v_mfma_f32_32x32x16_bf16 v[112:127], v[52:55], a[132:135], v[112:127]
    s_waitcnt lgkmcnt(6)
    v_mfma_f32_32x32x16_bf16 v[64:79], v[56:59], a[136:139], v[64:79]
    ds_read_b128 a[152:155], v17 offset:0
    ds_read_b128 a[156:159], v21 offset:0
    v_mfma_f32_32x32x16_bf16 v[80:95], v[56:59], a[140:143], v[80:95]
    ds_read_b64_tr_b16 v[48:49], v22 offset:12288
    ds_read_b64_tr_b16 v[50:51], v22 offset:13312
    v_mfma_f32_32x32x16_bf16 v[96:111], v[60:63], a[136:139], v[96:111]
    ds_read_b64_tr_b16 v[52:53], v22 offset:12800
    ds_read_b64_tr_b16 v[54:55], v22 offset:13824
    v_mfma_f32_32x32x16_bf16 v[112:127], v[60:63], a[140:143], v[112:127]
    s_waitcnt vmcnt(8)
    s_barrier
    s_waitcnt lgkmcnt(6)
    v_mfma_f32_32x32x16_bf16 v[64:79], v[40:43], a[144:147], v[64:79]
    ds_read_b128 a[160:163], v14 offset:16384
    ds_read_b128 a[164:167], v18 offset:16384
    s_add_u32 s53, s52, 7
    s_and_b32 s53, s53, 7
    s_lshl_b32 s50, s45, 10
    s_add_u32 s50, s50, s53
    s_lshl_b32 s50, s50, 7
    s_mul_i32 s51, s53, 229376
    s_add_u32 m0, s63, 49152
    s_nop 0
    buffer_load_dwordx4 v2, s[4:7], s50 offen lds
    s_add_u32 m0, s63, 114688
    v_mfma_f32_32x32x16_bf16 v[80:95], v[40:43], a[148:151], v[80:95]
    ds_read_b64_tr_b16 v[56:57], v22 offset:16384
    ds_read_b64_tr_b16 v[58:59], v22 offset:17408
    buffer_load_dwordx4 v6, s[8:11], s51 offen lds
    s_add_u32 m0, s63, 53248
    v_mfma_f32_32x32x16_bf16 v[96:111], v[44:47], a[144:147], v[96:111]
    ds_read_b64_tr_b16 v[60:61], v22 offset:16896
    ds_read_b64_tr_b16 v[62:63], v22 offset:17920
    buffer_load_dwordx4 v3, s[4:7], s50 offen lds
    s_add_u32 m0, s63, 118784
    v_mfma_f32_32x32x16_bf16 v[112:127], v[44:47], a[148:151], v[112:127]
    s_waitcnt lgkmcnt(6)
    v_mfma_f32_32x32x16_bf16 v[64:79], v[48:51], a[152:155], v[64:79]
    ds_read_b128 a[168:171], v15 offset:16384
    ds_read_b128 a[172:175], v19 offset:16384
    buffer_load_dwordx4 v7, s[8:11], s51 offen lds
    s_add_u32 m0, s63, 57344
    v_mfma_f32_32x32x16_bf16 v[80:95], v[48:51], a[156:159], v[80:95]
    ds_read_b64_tr_b16 v[40:41], v22 offset:20480
    ds_read_b64_tr_b16 v[42:43], v22 offset:21504
    buffer_load_dwordx4 v4, s[4:7], s50 offen lds
    s_add_u32 m0, s63, 122880
    v_mfma_f32_32x32x16_bf16 v[96:111], v[52:55], a[152:155], v[96:111]
    ds_read_b64_tr_b16 v[44:45], v22 offset:20992
    ds_read_b64_tr_b16 v[46:47], v22 offset:22016
    v_mfma_f32_32x32x16_bf16 v[112:127], v[52:55], a[156:159], v[112:127]
    buffer_load_dwordx4 v8, s[8:11], s51 offen lds
    s_add_u32 m0, s63, 61440
    s_waitcnt lgkmcnt(6)
    v_mfma_f32_32x32x16_bf16 v[64:79], v[56:59], a[160:163], v[64:79]
    ds_read_b128 a[176:179], v16 offset:16384
    ds_read_b128 a[180:183], v20 offset:16384
    buffer_load_dwordx4 v5, s[4:7], s50 offen lds
    s_add_u32 m0, s63, 126976
    v_mfma_f32_32x32x16_bf16 v[80:95], v[56:59], a[164:167], v[80:95]
    ds_read_b64_tr_b16 v[48:49], v22 offset:24576
    ds_read_b64_tr_b16 v[50:51], v22 offset:25600
    v_mfma_f32_32x32x16_bf16 v[96:111], v[60:63], a[160:163], v[96:111]
    ds_read_b64_tr_b16 v[52:53], v22 offset:25088
    ds_read_b64_tr_b16 v[54:55], v22 offset:26112
    buffer_load_dwordx4 v9, s[8:11], s51 offen lds
    v_mfma_f32_32x32x16_bf16 v[112:127], v[60:63], a[164:167], v[112:127]
    s_waitcnt lgkmcnt(6)
    v_mfma_f32_32x32x16_bf16 v[64:79], v[40:43], a[168:171], v[64:79]
    ds_read_b128 a[184:187], v17 offset:16384
    ds_read_b128 a[188:191], v21 offset:16384
    v_mfma_f32_32x32x16_bf16 v[80:95], v[40:43], a[172:175], v[80:95]
    ds_read_b64_tr_b16 v[56:57], v22 offset:28672
    ds_read_b64_tr_b16 v[58:59], v22 offset:29696
    v_mfma_f32_32x32x16_bf16 v[96:111], v[44:47], a[168:171], v[96:111]
    ds_read_b64_tr_b16 v[60:61], v22 offset:29184
    ds_read_b64_tr_b16 v[62:63], v22 offset:30208
    v_mfma_f32_32x32x16_bf16 v[112:127], v[44:47], a[172:175], v[112:127]
    s_waitcnt vmcnt(8)
    s_barrier
    s_mov_b32 s97, 0
    s_load_dword s97, s[40:41], 0x0
    s_waitcnt lgkmcnt(6)
    v_mfma_f32_32x32x16_bf16 v[64:79], v[48:51], a[176:179], v[64:79]
    ds_read_b128 a[192:195], v14 offset:32768
    ds_read_b128 a[196:199], v18 offset:32768
    s_add_u32 s53, s52, 0
    s_and_b32 s53, s53, 7
    s_mul_i32 s51, s53, 229376
    s_add_u32 m0, s55, 0
    s_nop 0
    buffer_load_dwordx4 v10, s[8:11], s51 offen lds
    s_add_u32 m0, s55, 1024
    v_mfma_f32_32x32x16_bf16 v[80:95], v[48:51], a[180:183], v[80:95]
    ds_read_b64_tr_b16 v[40:41], v22 offset:32768
    ds_read_b64_tr_b16 v[42:43], v22 offset:33792
    buffer_load_dwordx4 v11, s[8:11], s51 offen lds
    s_add_u32 m0, s55, 2048
    v_mfma_f32_32x32x16_bf16 v[96:111], v[52:55], a[176:179], v[96:111]
    ds_read_b64_tr_b16 v[44:45], v22 offset:33280
    ds_read_b64_tr_b16 v[46:47], v22 offset:34304
    v_mfma_f32_32x32x16_bf16 v[112:127], v[52:55], a[180:183], v[112:127]
    buffer_load_dwordx4 v12, s[8:11], s51 offen lds
    s_add_u32 m0, s55, 3072
    s_waitcnt lgkmcnt(6)
    v_mfma_f32_32x32x16_bf16 v[64:79], v[56:59], a[184:187], v[64:79]
    ds_read_b128 a[200:203], v15 offset:32768
    ds_read_b128 a[204:207], v19 offset:32768
    v_mfma_f32_32x32x16_bf16 v[80:95], v[56:59], a[188:191], v[80:95]
    ds_read_b64_tr_b16 v[48:49], v22 offset:36864
    ds_read_b64_tr_b16 v[50:51], v22 offset:37888
    buffer_load_dwordx4 v13, s[8:11], s51 offen lds
    s_add_u32 s53, s52, 1
    s_and_b32 s53, s53, 7
    s_mul_i32 s51, s53, 229376
    s_add_u32 m0, s55, 65536
    v_mfma_f32_32x32x16_bf16 v[96:111], v[60:63], a[184:187], v[96:111]
    ds_read_b64_tr_b16 v[52:53], v22 offset:37376
    ds_read_b64_tr_b16 v[54:55], v22 offset:38400
    v_mfma_f32_32x32x16_bf16 v[112:127], v[60:63], a[188:191], v[112:127]
    s_waitcnt lgkmcnt(6)
    v_mfma_f32_32x32x16_bf16 v[64:79], v[40:43], a[192:195], v[64:79]
    ds_read_b128 a[208:211], v16 offset:32768
    ds_read_b128 a[212:215], v20 offset:32768
    buffer_load_dwordx4 v10, s[8:11], s51 offen lds
    s_add_u32 m0, s55, 66560
    v_mfma_f32_32x32x16_bf16 v[80:95], v[40:43], a[196:199], v[80:95]
    ds_read_b64_tr_b16 v[56:57], v22 offset:40960
    ds_read_b64_tr_b16 v[58:59], v22 offset:41984
    v_mfma_f32_32x32x16_bf16 v[96:111], v[44:47], a[192:195], v[96:111]
    ds_read_b64_tr_b16 v[60:61], v22 offset:41472
    ds_read_b64_tr_b16 v[62:63], v22 offset:42496
    buffer_load_dwordx4 v11, s[8:11], s51 offen lds
    s_add_u32 m0, s55, 67584
    v_mfma_f32_32x32x16_bf16 v[112:127], v[44:47], a[196:199], v[112:127]
    s_waitcnt lgkmcnt(6)
    v_mfma_f32_32x32x16_bf16 v[64:79], v[48:51], a[200:203], v[64:79]
    ds_read_b128 a[216:219], v17 offset:32768
    ds_read_b128 a[220:223], v21 offset:32768
    v_mfma_f32_32x32x16_bf16 v[80:95], v[48:51], a[204:207], v[80:95]
    ds_read_b64_tr_b16 v[40:41], v22 offset:45056
    ds_read_b64_tr_b16 v[42:43], v22 offset:46080
    buffer_load_dwordx4 v12, s[8:11], s51 offen lds
    s_add_u32 m0, s55, 68608
    v_mfma_f32_32x32x16_bf16 v[96:111], v[52:55], a[200:203], v[96:111]
    ds_read_b64_tr_b16 v[44:45], v22 offset:45568
    ds_read_b64_tr_b16 v[46:47], v22 offset:46592
    v_mfma_f32_32x32x16_bf16 v[112:127], v[52:55], a[204:207], v[112:127]
    buffer_load_dwordx4 v13, s[8:11], s51 offen lds
    s_waitcnt vmcnt(8)
    s_barrier
    s_cmp_lt_u32 s97, 32
    s_cbranch_scc1 LQ_i1
LQ_id2:
    s_waitcnt lgkmcnt(6)
    v_mfma_f32_32x32x16_bf16 v[64:79], v[56:59], a[208:211], v[64:79]
    ds_read_b128 a[224:227], v14 offset:49152
    ds_read_b128 a[228:231], v18 offset:49152
    v_mfma_f32_32x32x16_bf16 v[80:95], v[56:59], a[212:215], v[80:95]
    ds_read_b64_tr_b16 v[48:49], v22 offset:49152
    ds_read_b64_tr_b16 v[50:51], v22 offset:50176
    v_mfma_f32_32x32x16_bf16 v[96:111], v[60:63], a[208:211], v[96:111]
    ds_read_b64_tr_b16 v[52:53], v22 offset:49664
    ds_read_b64_tr_b16 v[54:55], v22 offset:50688
    s_add_u32 s53, s52, 2
    s_and_b32 s53, s53, 7
    s_mul_i32 s51, s53, 229376
    s_add_u32 m0, s55, 16384
    s_nop 0
    buffer_load_dwordx4 v10, s[8:11], s51 offen lds
    s_add_u32 m0, s55, 17408
    v_mfma_f32_32x32x16_bf16 v[112:127], v[60:63], a[212:215], v[112:127]
    s_waitcnt lgkmcnt(6)
    v_mfma_f32_32x32x16_bf16 v[64:79], v[40:43], a[216:219], v[64:79]
    ds_read_b128 a[232:235], v15 offset:49152
    ds_read_b128 a[236:239], v19 offset:49152
    buffer_load_dwordx4 v11, s[8:11], s51 offen lds
    s_add_u32 m0, s55, 18432
    v_mfma_f32_32x32x16_bf16 v[80:95], v[40:43], a[220:223], v[80:95]
    ds_read_b64_tr_b16 v[56:57], v22 offset:53248
    ds_read_b64_tr_b16 v[58:59], v22 offset:54272
    v_mfma_f32_32x32x16_bf16 v[96:111], v[44:47], a[216:219], v[96:111]
    ds_read_b64_tr_b16 v[60:61], v22 offset:53760
    ds_read_b64_tr_b16 v[62:63], v22 offset:54784
    v_mfma_f32_32x32x16_bf16 v[112:127], v[44:47], a[220:223], v[112:127]
    buffer_load_dwordx4 v12, s[8:11], s51 offen lds
    s_add_u32 m0, s55, 19456
    s_waitcnt lgkmcnt(6)
    v_mfma_f32_32x32x16_bf16 v[64:79], v[48:51], a[224:227], v[64:79]
    ds_read_b128 a[240:243], v16 offset:49152
    ds_read_b128 a[244:247], v20 offset:49152
    ds_read_b64_tr_b16 v[40:41], v22 offset:57344
    ds_read_b64_tr_b16 v[42:43], v22 offset:58368
    ds_read_b64_tr_b16 v[44:45], v22 offset:57856
    ds_read_b64_tr_b16 v[46:47], v22 offset:58880
    s_waitcnt lgkmcnt(6)
    v_mfma_f32_32x32x16_bf16 v[64:79], v[56:59], a[232:235], v[64:79]
    ds_read_b128 a[248:251], v17 offset:49152
    ds_read_b128 a[252:255], v21 offset:49152
    ds_read_b64_tr_b16 v[196:197], v22 offset:61440
    ds_read_b64_tr_b16 v[198:199], v22 offset:62464
    ds_read_b64_tr_b16 v[200:201], v22 offset:61952
    ds_read_b64_tr_b16 v[202:203], v22 offset:62976
    s_waitcnt lgkmcnt(6)
    v_mfma_f32_32x32x16_bf16 v[64:79], v[40:43], a[240:243], v[64:79]
    buffer_load_dwordx4 v13, s[8:11], s51 offen lds
    s_add_u32 s53, s52, 3
    s_and_b32 s53, s53, 7
    s_mul_i32 s51, s53, 229376
    s_add_u32 m0, s55, 81920
    s_waitcnt lgkmcnt(0)
    v_mfma_f32_32x32x16_bf16 v[64:79], v[196:199], a[248:251], v[64:79]
    s_barrier
    v_mfma_f32_32x32x16_bf16 v[80:95], v[48:51], a[228:231], v[80:95]
    buffer_load_dwordx4 v10, s[8:11], s51 offen lds
    s_add_u32 m0, s55, 82944
    v_mfma_f32_32x32x16_bf16 v[80:95], v[56:59], a[236:239], v[80:95]
    v_mfma_f32_32x32x16_bf16 v[80:95], v[40:43], a[244:247], v[80:95]
    buffer_load_dwordx4 v11, s[8:11], s51 offen lds
    s_add_u32 m0, s55, 83968
    s_nop 3
    v_max_f32 v64, 0, v64
    v_max_f32 v65, 0, v65
    v_max_f32 v66, 0, v66
    v_max_f32 v67, 0, v67
    v_mfma_f32_32x32x16_bf16 v[80:95], v[196:199], a[252:255], v[80:95]
    v_max_f32 v68, 0, v68
    v_max_f32 v69, 0, v69
    v_max_f32 v70, 0, v70
    v_max_f32 v71, 0, v71
    v_mul_f32 v64, v64, v64
    v_mul_f32 v65, v65, v65
    v_mfma_f32_32x32x16_bf16 v[96:111], v[52:55], a[224:227], v[96:111]
    v_mul_f32 v66, v66, v66
    v_mul_f32 v67, v67, v67
    v_mul_f32 v68, v68, v68
    v_mul_f32 v69, v69, v69
    v_mul_f32 v70, v70, v70
    v_mul_f32 v71, v71, v71
    v_mfma_f32_32x32x16_bf16 v[96:111], v[60:63], a[232:235], v[96:111]
    buffer_load_dwordx4 v12, s[8:11], s51 offen lds
    s_add_u32 m0, s55, 84992
    v_cvt_pk_bf16_f32 v64, v64, v65
    v_cvt_pk_bf16_f32 v65, v66, v67
    v_cvt_pk_bf16_f32 v66, v68, v69
    v_mfma_f32_32x32x16_bf16 v[96:111], v[44:47], a[240:243], v[96:111]
    v_cvt_pk_bf16_f32 v67, v70, v71
    buffer_store_dwordx4 v[64:67], v32, s[24:27], s3 offen sc1
    v_max_f32 v72, 0, v72
    v_max_f32 v73, 0, v73
    v_max_f32 v74, 0, v74
    v_mfma_f32_32x32x16_bf16 v[96:111], v[200:203], a[248:251], v[96:111]
    buffer_load_dwordx4 v13, s[8:11], s51 offen lds
    s_add_u32 s53, s52, 4
    s_and_b32 s53, s53, 7
    s_mul_i32 s51, s53, 229376
    s_add_u32 m0, s55, 32768
    v_max_f32 v75, 0, v75
    v_mfma_f32_32x32x16_bf16 v[112:127], v[52:55], a[228:231], v[112:127]
    v_max_f32 v76, 0, v76
    v_max_f32 v77, 0, v77
    v_max_f32 v78, 0, v78
    v_max_f32 v79, 0, v79
    s_add_u32 s54, s3, 16384
    v_mul_f32 v72, v72, v72
    v_mfma_f32_32x32x16_bf16 v[112:127], v[60:63], a[236:239], v[112:127]
    v_mul_f32 v73, v73, v73
    v_mul_f32 v74, v74, v74
    v_mul_f32 v75, v75, v75
    v_mul_f32 v76, v76, v76
    v_mul_f32 v77, v77, v77
    v_mul_f32 v78, v78, v78
    v_mfma_f32_32x32x16_bf16 v[112:127], v[44:47], a[244:247], v[112:127]
    buffer_load_dwordx4 v10, s[8:11], s51 offen lds
    s_add_u32 m0, s55, 33792
    v_mul_f32 v79, v79, v79
    v_cvt_pk_bf16_f32 v72, v72, v73
    v_cvt_pk_bf16_f32 v73, v74, v75
    v_mfma_f32_32x32x16_bf16 v[112:127], v[200:203], a[252:255], v[112:127]
    v_cvt_pk_bf16_f32 v74, v76, v77
    v_cvt_pk_bf16_f32 v75, v78, v79
    buffer_store_dwordx4 v[72:75], v32, s[24:27], s54 offen sc1
    v_max_f32 v80, 0, v80
    v_max_f32 v81, 0, v81
    v_max_f32 v82, 0, v82
    v_max_f32 v83, 0, v83
    v_max_f32 v84, 0, v84
    v_max_f32 v85, 0, v85
    v_max_f32 v86, 0, v86
    v_max_f32 v87, 0, v87
    v_mul_f32 v80, v80, v80
    v_mul_f32 v81, v81, v81
    v_mul_f32 v82, v82, v82
    v_mul_f32 v83, v83, v83
    v_mul_f32 v84, v84, v84
    v_mul_f32 v85, v85, v85
    v_mul_f32 v86, v86, v86
    v_mul_f32 v87, v87, v87
    v_cvt_pk_bf16_f32 v80, v80, v81
    v_cvt_pk_bf16_f32 v81, v82, v83
    v_cvt_pk_bf16_f32 v82, v84, v85
    v_cvt_pk_bf16_f32 v83, v86, v87
    buffer_store_dwordx4 v[80:83], v33, s[24:27], s3 offen sc1
    v_max_f32 v88, 0, v88
    v_max_f32 v89, 0, v89
    v_max_f32 v90, 0, v90
    v_max_f32 v91, 0, v91
    v_max_f32 v92, 0, v92
    v_max_f32 v93, 0, v93
    v_max_f32 v94, 0, v94
    v_max_f32 v95, 0, v95
    s_add_u32 s54, s3, 16384
    v_mul_f32 v88, v88, v88
    v_mul_f32 v89, v89, v89
    v_mul_f32 v90, v90, v90
    v_mul_f32 v91, v91, v91
    v_mul_f32 v92, v92, v92
    v_mul_f32 v93, v93, v93
    v_mul_f32 v94, v94, v94
    v_mul_f32 v95, v95, v95
    v_cvt_pk_bf16_f32 v88, v88, v89
    v_cvt_pk_bf16_f32 v89, v90, v91
    v_cvt_pk_bf16_f32 v90, v92, v93
    v_cvt_pk_bf16_f32 v91, v94, v95
    buffer_store_dwordx4 v[88:91], v33, s[24:27], s54 offen sc1
    v_max_f32 v96, 0, v96
    v_max_f32 v97, 0, v97
    v_max_f32 v98, 0, v98
    v_max_f32 v99, 0, v99
    v_max_f32 v100, 0, v100
    v_max_f32 v101, 0, v101
    v_max_f32 v102, 0, v102
    v_max_f32 v103, 0, v103
    v_pk_mul_f32 v[96:97], v[96:97], v[96:97]
    v_pk_mul_f32 v[98:99], v[98:99], v[98:99]
    v_pk_mul_f32 v[100:101], v[100:101], v[100:101]
    v_pk_mul_f32 v[102:103], v[102:103], v[102:103]
    v_cvt_pk_bf16_f32 v96, v96, v97
    v_cvt_pk_bf16_f32 v97, v98, v99
    v_cvt_pk_bf16_f32 v98, v100, v101
    v_cvt_pk_bf16_f32 v99, v102, v103
    buffer_store_dwordx4 v[96:99], v32, s[24:27], s2 offen sc1
    v_max_f32 v104, 0, v104
    v_max_f32 v105, 0, v105
    v_max_f32 v106, 0, v106
    v_max_f32 v107, 0, v107
    v_max_f32 v108, 0, v108
    v_max_f32 v109, 0, v109
    v_max_f32 v110, 0, v110
    v_max_f32 v111, 0, v111
    s_add_u32 s54, s2, 16384
    v_pk_mul_f32 v[104:105], v[104:105], v[104:105]
    v_pk_mul_f32 v[106:107], v[106:107], v[106:107]
    v_pk_mul_f32 v[108:109], v[108:109], v[108:109]
    v_pk_mul_f32 v[110:111], v[110:111], v[110:111]
    v_cvt_pk_bf16_f32 v104, v104, v105
    v_cvt_pk_bf16_f32 v105, v106, v107
    v_cvt_pk_bf16_f32 v106, v108, v109
    v_cvt_pk_bf16_f32 v107, v110, v111
    buffer_store_dwordx4 v[104:107], v32, s[24:27], s54 offen sc1
    s_waitcnt vmcnt(19)
    s_barrier
    ds_read_b64_tr_b16 v[56:57], v23 offset:0
    ds_read_b64_tr_b16 v[58:59], v23 offset:1024
    ds_read_b64_tr_b16 v[60:61], v25 offset:0
    ds_read_b64_tr_b16 v[62:63], v25 offset:1024
    ds_read_b64_tr_b16 v[40:41], v23 offset:4096
    ds_read_b64_tr_b16 v[42:43], v23 offset:5120
    ds_read_b64_tr_b16 v[44:45], v25 offset:4096
    ds_read_b64_tr_b16 v[46:47], v25 offset:5120
    v_max_f32 v112, 0, v112
    v_max_f32 v113, 0, v113
    v_max_f32 v114, 0, v114
    v_max_f32 v115, 0, v115
    v_max_f32 v116, 0, v116
    v_max_f32 v117, 0, v117
    v_max_f32 v118, 0, v118
    v_max_f32 v119, 0, v119
    v_pk_mul_f32 v[112:113], v[112:113], v[112:113]
    v_pk_mul_f32 v[114:115], v[114:115], v[114:115]
    v_pk_mul_f32 v[116:117], v[116:117], v[116:117]
    v_pk_mul_f32 v[118:119], v[118:119], v[118:119]
    v_cvt_pk_bf16_f32 v112, v112, v113
    v_cvt_pk_bf16_f32 v113, v114, v115
    v_cvt_pk_bf16_f32 v114, v116, v117
    v_cvt_pk_bf16_f32 v115, v118, v119
    buffer_store_dwordx4 v[112:115], v33, s[24:27], s2 offen sc1
    v_max_f32 v120, 0, v120
    v_max_f32 v121, 0, v121
    v_max_f32 v122, 0, v122
    v_max_f32 v123, 0, v123
    v_max_f32 v124, 0, v124
    v_max_f32 v125, 0, v125
    v_max_f32 v126, 0, v126
    v_max_f32 v127, 0, v127
    s_add_u32 s54, s2, 16384
    v_pk_mul_f32 v[120:121], v[120:121], v[120:121]
    v_pk_mul_f32 v[122:123], v[122:123], v[122:123]
    v_pk_mul_f32 v[124:125], v[124:125], v[124:125]
    v_pk_mul_f32 v[126:127], v[126:127], v[126:127]
    v_cvt_pk_bf16_f32 v120, v120, v121
    v_cvt_pk_bf16_f32 v121, v122, v123
    v_cvt_pk_bf16_f32 v122, v124, v125
    v_cvt_pk_bf16_f32 v123, v126, v127
    buffer_store_dwordx4 v[120:123], v33, s[24:27], s54 offen sc1
    s_mov_b32 s60, 0
    s_branch LQ_po15
LQ_ph4:
    s_waitcnt vmcnt(7)
    s_atomic_add s0, s[24:25], s58
    s_brev_b32 s60, 1
    s_branch LQ_ps3
LQ_ph6:
    s_waitcnt vmcnt(9)
    s_atomic_add s0, s[24:25], s58
    s_brev_b32 s60, 1
    s_branch LQ_ps5
LQ_ph8:
    s_waitcnt vmcnt(11)
    s_atomic_add s0, s[24:25], s58
    s_brev_b32 s60, 1
    s_branch LQ_ps7
LQ_ph10:
    s_waitcnt vmcnt(13)
    s_atomic_add s0, s[24:25], s58
    s_brev_b32 s60, 1
    s_branch LQ_ps9
LQ_ph12:
    s_waitcnt vmcnt(16)
    s_atomic_add s0, s[24:25], s58
    s_brev_b32 s60, 1
    s_branch LQ_ps11
LQ_ph14:
    s_waitcnt vmcnt(17)
    s_atomic_add s0, s[24:25], s58
    s_branch LQ_pf13
LQ_po15:
    s_waitcnt lgkmcnt(4)
    v_mfma_f32_32x32x16_bf16 v[128:143], v[56:59], a[0:3], v[208:223]
    ds_read_b64_tr_b16 v[48:49], v23 offset:8192
    ds_read_b64_tr_b16 v[50:51], v23 offset:9216
    s_add_u32 s37, s48, 1
    s_and_b32 s37, s37, 3
    s_mul_i32 s37, s37, 24576
    s_add_u32 s37, s37, s62
    s_add_u32 s4, s37, 0
    v_mfma_f32_32x32x16_bf16 v[144:159], v[56:59], a[4:7], v[208:223]
    ds_read_b64_tr_b16 v[52:53], v25 offset:8192
    ds_read_b64_tr_b16 v[54:55], v25 offset:9216
    s_add_u32 s37, s48, 2
    s_and_b32 s37, s37, 3
    s_mul_i32 s37, s37, 24576
    s_add_u32 s37, s37, s62
    s_add_u32 s5, s37, 2048
    v_mfma_f32_32x32x16_bf16 v[160:175], v[60:63], a[0:3], v[224:239]
    s_add_u32 s37, s48, 3
    s_and_b32 s37, s37, 3
    s_mul_i32 s37, s37, 24576
    s_add_u32 s37, s37, s62
    s_add_u32 s6, s37, 4096
    v_and_b32 v15, 31, v1
    s_waitcnt lgkmcnt(4)
    v_mfma_f32_32x32x16_bf16 v[128:143], v[40:43], a[8:11], v[128:143]
    ds_read_b64_tr_b16 v[56:57], v23 offset:12288
    ds_read_b64_tr_b16 v[58:59], v23 offset:13312
    s_mul_i32 s41, s42, 2560
    s_add_u32 s41, s41, 147456
    v_mul_u32_u24 v14, 80, v15
    v_lshrrev_b32 v16, 5, v1
    v_mfma_f32_32x32x16_bf16 v[144:159], v[40:43], a[12:15], v[144:159]
    ds_read_b64_tr_b16 v[60:61], v25 offset:12288
    ds_read_b64_tr_b16 v[62:63], v25 offset:13312
    v_lshl_add_u32 v14, v16, 3, v14
    v_add_u32 v18, s41, v14
    v_lshrrev_b32 v14, 2, v1
    v_and_b32 v16, 3, v1
    v_mfma_f32_32x32x16_bf16 v[160:175], v[44:47], a[8:11], v[160:175]
    buffer_load_dwordx4 v11, s[8:11], s51 offen lds
    s_add_u32 m0, s55, 34816
    v_lshlrev_b32 v16, 4, v16
    v_mul_u32_u24 v17, 80, v14
    v_add3_u32 v19, v17, v16, s41
    v_lshl_add_u32 v20, v14, 10, v16
    s_waitcnt vmcnt(18)
    s_barrier
    s_waitcnt lgkmcnt(4)
    v_mfma_f32_32x32x16_bf16 v[128:143], v[48:51], a[16:19], v[128:143]
    ds_read_b64_tr_b16 v[40:41], v24 offset:0
    ds_read_b64_tr_b16 v[42:43], v24 offset:1024
    s_lshl_b32 s40, s45, 2
    s_add_u32 s40, s40, s42
    s_lshl_b32 s40, s40, 15
    s_lshl_b32 s41, s49, 2
    v_mfma_f32_32x32x16_bf16 v[144:159], v[48:51], a[20:23], v[144:159]
    ds_read_b64_tr_b16 v[44:45], v26 offset:0
    ds_read_b64_tr_b16 v[46:47], v26 offset:1024
    buffer_load_dwordx4 v12, s[8:11], s51 offen lds
    s_add_u32 m0, s55, 35840
    s_add_u32 s41, s41, s48
    s_lshl_b32 s41, s41, 6
    v_mfma_f32_32x32x16_bf16 v[160:175], v[52:55], a[16:19], v[160:175]
    s_add_u32 s40, s40, s41
    s_add_u32 s41, s40, 0x4000
    s_waitcnt lgkmcnt(4)
    v_mfma_f32_32x32x16_bf16 v[128:143], v[56:59], a[24:27], v[128:143]
    ds_read_b64_tr_b16 v[48:49], v24 offset:4096
    ds_read_b64_tr_b16 v[50:51], v24 offset:5120
    buffer_load_dwordx4 v13, s[8:11], s51 offen lds
    s_add_u32 s50, s100, 0
    s_add_u32 m0, s63, 131072
    v_mfma_f32_32x32x16_bf16 v[144:159], v[56:59], a[28:31], v[144:159]
    ds_read_b64_tr_b16 v[52:53], v26 offset:4096
    ds_read_b64_tr_b16 v[54:55], v26 offset:5120
    v_mfma_f32_32x32x16_bf16 v[160:175], v[60:63], a[24:27], v[160:175]
    s_waitcnt lgkmcnt(4)
    v_mfma_f32_32x32x16_bf16 v[128:143], v[40:43], a[32:35], v[128:143]
    ds_read_b64_tr_b16 v[56:57], v24 offset:8192
    ds_read_b64_tr_b16 v[58:59], v24 offset:9216
    buffer_load_dwordx4 v27, s[20:23], s50 offen lds
    s_add_u32 s50, s100, 16384
    s_add_u32 m0, s63, 135168
    v_mfma_f32_32x32x16_bf16 v[144:159], v[40:43], a[36:39], v[144:159]
    ds_read_b64_tr_b16 v[60:61], v26 offset:8192
    ds_read_b64_tr_b16 v[62:63], v26 offset:9216
    v_mfma_f32_32x32x16_bf16 v[160:175], v[44:47], a[32:35], v[160:175]
    buffer_load_dwordx4 v27, s[20:23], s50 offen lds
    s_add_u32 s50, s100, 32768
    s_add_u32 m0, s63, 139264
    s_waitcnt lgkmcnt(4)
    v_mfma_f32_32x32x16_bf16 v[128:143], v[48:51], a[40:43], v[128:143]
    ds_read_b64_tr_b16 v[40:41], v24 offset:12288
    ds_read_b64_tr_b16 v[42:43], v24 offset:13312
    v_mfma_f32_32x32x16_bf16 v[144:159], v[48:51], a[44:47], v[144:159]
    ds_read_b64_tr_b16 v[44:45], v26 offset:12288
    ds_read_b64_tr_b16 v[46:47], v26 offset:13312
    buffer_load_dwordx4 v27, s[20:23], s50 offen lds
    s_add_u32 s50, s100, 49152
    s_add_u32 m0, s63, 143360
    v_mfma_f32_32x32x16_bf16 v[160:175], v[52:55], a[40:43], v[160:175]
    s_waitcnt vmcnt(19)
    s_barrier
    s_waitcnt lgkmcnt(4)
    v_mfma_f32_32x32x16_bf16 v[128:143], v[56:59], a[48:51], v[128:143]
    ds_read_b64_tr_b16 v[48:49], v23 offset:16384
    ds_read_b64_tr_b16 v[50:51], v23 offset:17408
    buffer_load_dwordx4 v27, s[20:23], s50 offen lds
    s_add_u32 s53, s52, 5
    s_and_b32 s53, s53, 7
    s_mul_i32 s51, s53, 229376
    s_add_u32 m0, s55, 0
    s_getreg_b32 s37, hwreg(HW_REG_IB_STS)
    s_and_b32 s37, s37, 0xc0000f
    s_or_b32 s37, s37, s60
    s_cmp_le_u32 s37, 0x7
    s_cbranch_scc1 LQ_ph4
LQ_ps3:
    v_mfma_f32_32x32x16_bf16 v[144:159], v[56:59], a[52:55], v[144:159]
    ds_read_b64_tr_b16 v[52:53], v25 offset:16384
    ds_read_b64_tr_b16 v[54:55], v25 offset:17408
    v_mfma_f32_32x32x16_bf16 v[160:175], v[60:63], a[48:51], v[160:175]
    s_waitcnt lgkmcnt(4)
    v_mfma_f32_32x32x16_bf16 v[128:143], v[40:43], a[56:59], v[128:143]
    ds_read_b64_tr_b16 v[56:57], v23 offset:20480
    ds_read_b64_tr_b16 v[58:59], v23 offset:21504
    buffer_load_dwordx4 v10, s[8:11], s51 offen lds
    s_add_u32 m0, s55, 1024
    v_mfma_f32_32x32x16_bf16 v[144:159], v[40:43], a[60:63], v[144:159]
    ds_read_b64_tr_b16 v[60:61], v25 offset:20480
    ds_read_b64_tr_b16 v[62:63], v25 offset:21504
    v_mfma_f32_32x32x16_bf16 v[160:175], v[44:47], a[56:59], v[160:175]
    buffer_load_dwordx4 v11, s[8:11], s51 offen lds
    s_add_u32 m0, s55, 2048
    s_getreg_b32 s37, hwreg(HW_REG_IB_STS)
    s_and_b32 s37, s37, 0xc0000f
    s_or_b32 s37, s37, s60
    s_cmp_le_u32 s37, 0x9
    s_cbranch_scc1 LQ_ph6
LQ_ps5:
    s_waitcnt lgkmcnt(4)
    v_mfma_f32_32x32x16_bf16 v[128:143], v[48:51], a[64:67], v[128:143]
    ds_read_b64_tr_b16 v[40:41], v23 offset:24576
    ds_read_b64_tr_b16 v[42:43], v23 offset:25600
    v_mfma_f32_32x32x16_bf16 v[144:159], v[48:51], a[68:71], v[144:159]
    ds_read_b64_tr_b16 v[44:45], v25 offset:24576
    ds_read_b64_tr_b16 v[46:47], v25 offset:25600
    buffer_load_dwordx4 v12, s[8:11], s51 offen lds
    s_add_u32 m0, s55, 3072
    v_mfma_f32_32x32x16_bf16 v[160:175], v[52:55], a[64:67], v[160:175]
    s_waitcnt lgkmcnt(4)
    v_mfma_f32_32x32x16_bf16 v[128:143], v[56:59], a[72:75], v[128:143]
    ds_read_b64_tr_b16 v[48:49], v23 offset:28672
    ds_read_b64_tr_b16 v[50:51], v23 offset:29696
    buffer_load_dwordx4 v13, s[8:11], s51 offen lds
    s_add_u32 s50, s100, 65536
    s_add_u32 m0, s63, 98304
    v_mfma_f32_32x32x16_bf16 v[144:159], v[56:59], a[76:79], v[144:159]
    ds_read_b64_tr_b16 v[52:53], v25 offset:28672
    ds_read_b64_tr_b16 v[54:55], v25 offset:29696
    s_getreg_b32 s37, hwreg(HW_REG_IB_STS)
    s_and_b32 s37, s37, 0xc0000f
    s_or_b32 s37, s37, s60
    s_cmp_le_u32 s37, 0xb
    s_cbranch_scc1 LQ_ph8
LQ_ps7:
    v_mfma_f32_32x32x16_bf16 v[160:175], v[60:63], a[72:75], v[160:175]
    buffer_load_dwordx4 v27, s[20:23], s50 offen lds
    s_add_u32 s50, s100, 81920
    s_add_u32 m0, s63, 102400
    s_waitcnt vmcnt(20)
    s_barrier
    s_waitcnt lgkmcnt(4)
    v_mfma_f32_32x32x16_bf16 v[128:143], v[40:43], a[80:83], v[128:143]
    ds_read_b64_tr_b16 v[56:57], v24 offset:16384
    ds_read_b64_tr_b16 v[58:59], v24 offset:17408
    v_mfma_f32_32x32x16_bf16 v[144:159], v[40:43], a[84:87], v[144:159]
    ds_read_b64_tr_b16 v[60:61], v26 offset:16384
    ds_read_b64_tr_b16 v[62:63], v26 offset:17408
    buffer_load_dwordx4 v27, s[20:23], s50 offen lds
    s_add_u32 s53, s52, 6
    s_and_b32 s53, s53, 7
    s_mul_i32 s51, s53, 229376
    s_add_u32 m0, s55, 65536
    v_mfma_f32_32x32x16_bf16 v[160:175], v[44:47], a[80:83], v[160:175]
    s_waitcnt lgkmcnt(4)
    v_mfma_f32_32x32x16_bf16 v[128:143], v[48:51], a[88:91], v[128:143]
    ds_read_b64_tr_b16 v[40:41], v24 offset:20480
    ds_read_b64_tr_b16 v[42:43], v24 offset:21504
    s_getreg_b32 s37, hwreg(HW_REG_IB_STS)
    s_and_b32 s37, s37, 0xc0000f
    s_or_b32 s37, s37, s60
    s_cmp_le_u32 s37, 0xd
    s_cbranch_scc1 LQ_ph10
LQ_ps9:
    v_mfma_f32_32x32x16_bf16 v[144:159], v[48:51], a[92:95], v[144:159]
    ds_read_b64_tr_b16 v[44:45], v26 offset:20480
    ds_read_b64_tr_b16 v[46:47], v26 offset:21504
    buffer_load_dwordx4 v10, s[8:11], s51 offen lds
    s_add_u32 m0, s55, 66560
    v_mfma_f32_32x32x16_bf16 v[160:175], v[52:55], a[88:91], v[160:175]
    s_mov_b32 s96, 0
    s_atomic_umax s96, s[24:25], s58 glc
    s_waitcnt lgkmcnt(4)
    v_mfma_f32_32x32x16_bf16 v[128:143], v[56:59], a[96:99], v[128:143]
    ds_read_b64_tr_b16 v[48:49], v24 offset:24576
    ds_read_b64_tr_b16 v[50:51], v24 offset:25600
    buffer_load_dwordx4 v11, s[8:11], s51 offen lds
    s_add_u32 m0, s55, 67584
    v_mfma_f32_32x32x16_bf16 v[144:159], v[56:59], a[100:103], v[144:159]
    ds_read_b64_tr_b16 v[52:53], v26 offset:24576
    ds_read_b64_tr_b16 v[54:55], v26 offset:25600
    v_mfma_f32_32x32x16_bf16 v[160:175], v[60:63], a[96:99], v[160:175]
    buffer_load_dwordx4 v12, s[8:11], s51 offen lds
    s_add_u32 m0, s55, 68608
    s_getreg_b32 s37, hwreg(HW_REG_IB_STS)
    s_and_b32 s37, s37, 0xc0000f
    s_or_b32 s37, s37, s60
    s_cmp_le_u32 s37, 0x400000
    s_cbranch_scc1 LQ_ph12
LQ_ps11:
    s_waitcnt lgkmcnt(4)
    v_mfma_f32_32x32x16_bf16 v[128:143], v[40:43], a[104:107], v[128:143]
    ds_read_b64_tr_b16 v[56:57], v24 offset:28672
    ds_read_b64_tr_b16 v[58:59], v24 offset:29696
    v_mfma_f32_32x32x16_bf16 v[144:159], v[40:43], a[108:111], v[144:159]
    ds_read_b64_tr_b16 v[60:61], v26 offset:28672
    ds_read_b64_tr_b16 v[62:63], v26 offset:29696
    buffer_load_dwordx4 v13, s[8:11], s51 offen lds
    s_add_u32 s50, s100, 98304
    s_add_u32 m0, s63, 106496
    v_mfma_f32_32x32x16_bf16 v[160:175], v[44:47], a[104:107], v[160:175]
    s_waitcnt vmcnt(14)
    s_cmp_eq_u32 s60, 0
    s_cbranch_scc1 LQ_ph14
LQ_pf13:
    s_barrier
    s_waitcnt lgkmcnt(4)
    v_mfma_f32_32x32x16_bf16 v[128:143], v[48:51], a[112:115], v[128:143]
    ds_read_b64_tr_b16 v[40:41], v23 offset:32768
    ds_read_b64_tr_b16 v[42:43], v23 offset:33792
    buffer_load_dwordx4 v27, s[20:23], s50 offen lds
    s_add_u32 s53, s52, 7
    s_and_b32 s53, s53, 7
    s_mul_i32 s51, s53, 229376
    s_add_u32 m0, s55, 16384
    v_mfma_f32_32x32x16_bf16 v[144:159], v[48:51], a[116:119], v[144:159]
    ds_read_b64_tr_b16 v[44:45], v25 offset:32768
    ds_read_b64_tr_b16 v[46:47], v25 offset:33792
    v_mfma_f32_32x32x16_bf16 v[160:175], v[52:55], a[112:115], v[160:175]
    buffer_load_dwordx4 v10, s[8:11], s51 offen lds
    s_add_u32 m0, s55, 17408
    s_waitcnt lgkmcnt(4)
    v_mfma_f32_32x32x16_bf16 v[128:143], v[56:59], a[120:123], v[128:143]
    ds_read_b64_tr_b16 v[48:49], v23 offset:36864
    ds_read_b64_tr_b16 v[50:51], v23 offset:37888
    v_mfma_f32_32x32x16_bf16 v[144:159], v[56:59], a[124:127], v[144:159]
    ds_read_b64_tr_b16 v[52:53], v25 offset:36864
    ds_read_b64_tr_b16 v[54:55], v25 offset:37888
    buffer_load_dwordx4 v11, s[8:11], s51 offen lds
    s_add_u32 m0, s55, 18432
    v_mfma_f32_32x32x16_bf16 v[160:175], v[60:63], a[120:123], v[160:175]
    global_load_dword v253, v[248:249], off
    s_waitcnt lgkmcnt(4)
    v_mfma_f32_32x32x16_bf16 v[128:143], v[40:43], a[128:131], v[128:143]
    ds_read_b64_tr_b16 v[56:57], v23 offset:40960
    ds_read_b64_tr_b16 v[58:59], v23 offset:41984
    v_mfma_f32_32x32x16_bf16 v[144:159], v[40:43], a[132:135], v[144:159]
    ds_read_b64_tr_b16 v[60:61], v25 offset:40960
    ds_read_b64_tr_b16 v[62:63], v25 offset:41984
    v_mfma_f32_32x32x16_bf16 v[160:175], v[44:47], a[128:131], v[160:175]
    s_waitcnt lgkmcnt(4)
    v_mfma_f32_32x32x16_bf16 v[128:143], v[48:51], a[136:139], v[128:143]
    ds_read_b64_tr_b16 v[40:41], v23 offset:45056
    ds_read_b64_tr_b16 v[42:43], v23 offset:46080
    buffer_load_dwordx4 v12, s[8:11], s51 offen lds
    s_add_u32 m0, s55, 19456
    v_mfma_f32_32x32x16_bf16 v[144:159], v[48:51], a[140:143], v[144:159]
    ds_read_b64_tr_b16 v[44:45], v25 offset:45056
    ds_read_b64_tr_b16 v[46:47], v25 offset:46080
    v_mfma_f32_32x32x16_bf16 v[160:175], v[52:55], a[136:139], v[160:175]
    buffer_load_dwordx4 v13, s[8:11], s51 offen lds
    s_add_u32 s53, s100, 0
    s_bfe_u32 s37, s96, 0x80000
    s_cmp_ge_u32 s37, 4
    s_cbranch_scc1 LQ_gd17
LQ_g16:
    s_waitcnt lgkmcnt(0)
    s_bfe_u32 s37, s96, 0x80000
    s_cmp_ge_u32 s37, 4
    s_cbranch_scc1 LQ_gd17
LQ_ga18:
    s_cmp_eq_u32 s98, 0
    s_cbranch_scc1 LQ_gd17
    s_sub_u32 s98, s98, 1
    s_atomic_umax s96, s[24:25], s58 glc
    s_branch LQ_g16
LQ_gd17:
    s_waitcnt vmcnt(12)
    s_barrier
    s_waitcnt lgkmcnt(4)
    v_mfma_f32_32x32x16_bf16 v[128:143], v[56:59], a[144:147], v[128:143]
    ds_read_b64_tr_b16 v[48:49], v23 offset:0
    ds_read_b64_tr_b16 v[50:51], v23 offset:1024
    v_mfma_f32_32x32x16_bf16 v[144:159], v[56:59], a[148:151], v[144:159]
    ds_read_b64_tr_b16 v[52:53], v25 offset:0
    ds_read_b64_tr_b16 v[54:55], v25 offset:1024
    buffer_load_dwordx4 a[0:3], v32, s[24:27], s53 offen sc1
    s_add_u32 s53, s100, 16384
    v_mfma_f32_32x32x16_bf16 v[160:175], v[60:63], a[144:147], v[160:175]
    s_waitcnt lgkmcnt(4)
    v_mfma_f32_32x32x16_bf16 v[128:143], v[40:43], a[152:155], v[128:143]
    ds_read_b64_tr_b16 v[56:57], v23 offset:4096
    ds_read_b64_tr_b16 v[58:59], v23 offset:5120
    buffer_load_dwordx4 a[4:7], v32, s[24:27], s53 offen sc1
    s_add_u32 s53, s100, 32768
    v_mfma_f32_32x32x16_bf16 v[144:159], v[40:43], a[156:159], v[144:159]
    ds_read_b64_tr_b16 v[60:61], v25 offset:4096
    ds_read_b64_tr_b16 v[62:63], v25 offset:5120
    v_mfma_f32_32x32x16_bf16 v[160:175], v[44:47], a[152:155], v[160:175]
    s_waitcnt lgkmcnt(4)
    v_mfma_f32_32x32x16_bf16 v[128:143], v[48:51], a[160:163], v[128:143]
    ds_read_b64_tr_b16 v[40:41], v23 offset:8192
    ds_read_b64_tr_b16 v[42:43], v23 offset:9216
    buffer_load_dwordx4 a[8:11], v32, s[24:27], s53 offen sc1
    s_add_u32 s53, s100, 49152
    v_mfma_f32_32x32x16_bf16 v[144:159], v[48:51], a[164:167], v[144:159]
    ds_read_b64_tr_b16 v[44:45], v25 offset:8192
    ds_read_b64_tr_b16 v[46:47], v25 offset:9216
    v_mfma_f32_32x32x16_bf16 v[160:175], v[52:55], a[160:163], v[160:175]
    buffer_load_dwordx4 a[12:15], v32, s[24:27], s53 offen sc1
    s_add_u32 s53, s100, 65536
    s_waitcnt lgkmcnt(4)
    v_mfma_f32_32x32x16_bf16 v[128:143], v[56:59], a[168:171], v[128:143]
    ds_read_b64_tr_b16 v[48:49], v23 offset:12288
    ds_read_b64_tr_b16 v[50:51], v23 offset:13312
    v_mfma_f32_32x32x16_bf16 v[144:159], v[56:59], a[172:175], v[144:159]
    ds_read_b64_tr_b16 v[52:53], v25 offset:12288
    ds_read_b64_tr_b16 v[54:55], v25 offset:13312
    buffer_load_dwordx4 a[16:19], v32, s[24:27], s53 offen sc1
    s_add_u32 s53, s100, 81920
    v_mfma_f32_32x32x16_bf16 v[160:175], v[60:63], a[168:171], v[160:175]
    s_waitcnt vmcnt(11)
    s_barrier
    s_waitcnt lgkmcnt(4)
    v_mfma_f32_32x32x16_bf16 v[128:143], v[40:43], a[176:179], v[128:143]
    ds_read_b64_tr_b16 v[56:57], v24 offset:0
    ds_read_b64_tr_b16 v[58:59], v24 offset:1024
    buffer_load_dwordx4 a[20:23], v32, s[24:27], s53 offen sc1
    s_add_u32 s53, s100, 98304
    v_mfma_f32_32x32x16_bf16 v[144:159], v[40:43], a[180:183], v[144:159]
    ds_read_b64_tr_b16 v[60:61], v26 offset:0
    ds_read_b64_tr_b16 v[62:63], v26 offset:1024
    buffer_load_dwordx4 a[24:27], v32, s[24:27], s53 offen sc1
    s_add_u32 s53, s100, 114688
    v_mfma_f32_32x32x16_bf16 v[160:175], v[44:47], a[176:179], v[160:175]
    s_waitcnt lgkmcnt(4)
    v_mfma_f32_32x32x16_bf16 v[128:143], v[48:51], a[184:187], v[128:143]
    ds_read_b64_tr_b16 v[40:41], v24 offset:4096
    ds_read_b64_tr_b16 v[42:43], v24 offset:5120
    v_mfma_f32_32x32x16_bf16 v[144:159], v[48:51], a[188:191], v[144:159]
    ds_read_b64_tr_b16 v[44:45], v26 offset:4096
    ds_read_b64_tr_b16 v[46:47], v26 offset:5120
    buffer_load_dwordx4 a[28:31], v32, s[24:27], s53 offen sc1
    s_add_u32 s53, s101, 327680
    v_mfma_f32_32x32x16_bf16 v[160:175], v[52:55], a[184:187], v[160:175]
    s_waitcnt lgkmcnt(4)
    v_mfma_f32_32x32x16_bf16 v[128:143], v[56:59], a[192:195], v[128:143]
    ds_read_b64_tr_b16 v[48:49], v24 offset:8192
    ds_read_b64_tr_b16 v[50:51], v24 offset:9216
    buffer_load_dwordx4 a[32:35], v32, s[24:27], s53 offen sc1
    s_add_u32 s53, s101, 344064
    v_mfma_f32_32x32x16_bf16 v[144:159], v[56:59], a[196:199], v[144:159]
    ds_read_b64_tr_b16 v[52:53], v26 offset:8192
    ds_read_b64_tr_b16 v[54:55], v26 offset:9216
    v_mfma_f32_32x32x16_bf16 v[160:175], v[60:63], a[192:195], v[160:175]
    s_waitcnt lgkmcnt(4)
    v_mfma_f32_32x32x16_bf16 v[128:143], v[40:43], a[200:203], v[128:143]
    ds_read_b64_tr_b16 v[56:57], v24 offset:12288
    ds_read_b64_tr_b16 v[58:59], v24 offset:13312
    buffer_load_dwordx4 a[36:39], v32, s[24:27], s53 offen sc1
    s_add_u32 s53, s101, 360448
    v_mfma_f32_32x32x16_bf16 v[144:159], v[40:43], a[204:207], v[144:159]
    ds_read_b64_tr_b16 v[60:61], v26 offset:12288
    ds_read_b64_tr_b16 v[62:63], v26 offset:13312
    v_mfma_f32_32x32x16_bf16 v[160:175], v[44:47], a[200:203], v[160:175]
    buffer_load_dwordx4 a[40:43], v32, s[24:27], s53 offen sc1
    s_add_u32 s53, s101, 376832
    s_waitcnt vmcnt(11)
    s_barrier
    s_waitcnt lgkmcnt(4)
    v_mfma_f32_32x32x16_bf16 v[128:143], v[48:51], a[208:211], v[128:143]
    ds_read_b64_tr_b16 v[40:41], v23 offset:16384
    ds_read_b64_tr_b16 v[42:43], v23 offset:17408
    v_mfma_f32_32x32x16_bf16 v[144:159], v[48:51], a[212:215], v[144:159]
    ds_read_b64_tr_b16 v[44:45], v25 offset:16384
    ds_read_b64_tr_b16 v[46:47], v25 offset:17408
    buffer_load_dwordx4 a[44:47], v32, s[24:27], s53 offen sc1
    s_add_u32 s53, s101, 393216
    v_mfma_f32_32x32x16_bf16 v[160:175], v[52:55], a[208:211], v[160:175]
    s_waitcnt lgkmcnt(4)
    v_mfma_f32_32x32x16_bf16 v[128:143], v[56:59], a[216:219], v[128:143]
    ds_read_b64_tr_b16 v[48:49], v23 offset:20480
    ds_read_b64_tr_b16 v[50:51], v23 offset:21504
    buffer_load_dwordx4 a[48:51], v32, s[24:27], s53 offen sc1
    s_add_u32 s53, s101, 409600
    v_mfma_f32_32x32x16_bf16 v[144:159], v[56:59], a[220:223], v[144:159]
    ds_read_b64_tr_b16 v[52:53], v25 offset:20480
    ds_read_b64_tr_b16 v[54:55], v25 offset:21504
    v_mfma_f32_32x32x16_bf16 v[160:175], v[60:63], a[216:219], v[160:175]
    s_waitcnt lgkmcnt(4)
    v_mfma_f32_32x32x16_bf16 v[128:143], v[40:43], a[224:227], v[128:143]
    ds_read_b64_tr_b16 v[56:57], v23 offset:24576
    ds_read_b64_tr_b16 v[58:59], v23 offset:25600
    buffer_load_dwordx4 a[52:55], v32, s[24:27], s53 offen sc1
    s_add_u32 s53, s101, 425984
    v_mfma_f32_32x32x16_bf16 v[144:159], v[40:43], a[228:231], v[144:159]
    ds_read_b64_tr_b16 v[60:61], v25 offset:24576
    ds_read_b64_tr_b16 v[62:63], v25 offset:25600
    v_mfma_f32_32x32x16_bf16 v[160:175], v[44:47], a[224:227], v[160:175]
    buffer_load_dwordx4 a[56:59], v32, s[24:27], s53 offen sc1
    s_add_u32 s53, s101, 442368
    s_waitcnt lgkmcnt(4)
    v_mfma_f32_32x32x16_bf16 v[128:143], v[48:51], a[232:235], v[128:143]
    ds_read_b64_tr_b16 v[40:41], v23 offset:28672
    ds_read_b64_tr_b16 v[42:43], v23 offset:29696
    v_mfma_f32_32x32x16_bf16 v[144:159], v[48:51], a[236:239], v[144:159]
    ds_read_b64_tr_b16 v[44:45], v25 offset:28672
    ds_read_b64_tr_b16 v[46:47], v25 offset:29696
    buffer_load_dwordx4 a[60:63], v32, s[24:27], s53 offen sc1
    s_add_u32 s50, s100, 114688
    s_add_u32 m0, s63, 110592
    v_mfma_f32_32x32x16_bf16 v[160:175], v[52:55], a[232:235], v[160:175]
    s_barrier
    s_waitcnt lgkmcnt(4)
    v_mfma_f32_32x32x16_bf16 v[128:143], v[56:59], a[240:243], v[128:143]
    v_mfma_f32_32x32x16_bf16 v[144:159], v[56:59], a[244:247], v[144:159]
    buffer_load_dwordx4 v27, s[20:23], s50 offen lds
    s_add_u32 s50, s101, 327680
    s_add_u32 m0, s63, 49152
    v_mfma_f32_32x32x16_bf16 v[160:175], v[60:63], a[240:243], v[160:175]
    s_waitcnt lgkmcnt(0)
    v_mfma_f32_32x32x16_bf16 v[128:143], v[40:43], a[248:251], v[128:143]
    buffer_load_dwordx4 v27, s[20:23], s50 offen lds
    s_add_u32 s50, s101, 344064
    s_add_u32 m0, s63, 53248
    v_mfma_f32_32x32x16_bf16 v[144:159], v[40:43], a[252:255], v[144:159]
    v_mfma_f32_32x32x16_bf16 v[160:175], v[44:47], a[248:251], v[160:175]
    buffer_load_dwordx4 v27, s[20:23], s50 offen lds
    s_add_u32 s50, s101, 360448
    s_add_u32 m0, s63, 57344
    s_barrier
    s_lshl_b32 s37, s49, 2
    s_add_u32 s37, s37, s48
    s_lshl_b32 s37, s37, 6
    v_lshrrev_b32 v24, 5, v1
    v_lshl_add_u32 v24, v24, 3, s37
    global_load_dwordx2 v[10:11], v24, s[38:39] offset:0
    global_load_dwordx2 v[12:13], v24, s[38:39] offset:16
    global_load_dwordx2 v[14:15], v24, s[38:39] offset:32
    global_load_dwordx2 v[16:17], v24, s[38:39] offset:48
    v_max_f32 v128, 0, v128
    v_max_f32 v129, 0, v129
    v_max_f32 v130, 0, v130
    v_max_f32 v131, 0, v131
    v_max_f32 v132, 0, v132
    v_max_f32 v133, 0, v133
    v_max_f32 v134, 0, v134
    v_max_f32 v135, 0, v135
    v_pk_mul_f32 v[128:129], v[128:129], v[128:129]
    v_pk_mul_f32 v[130:131], v[130:131], v[130:131]
    v_pk_mul_f32 v[132:133], v[132:133], v[132:133]
    v_pk_mul_f32 v[134:135], v[134:135], v[134:135]
    v_cvt_pk_bf16_f32 v128, v128, v129
    v_cvt_pk_bf16_f32 v129, v130, v131
    v_cvt_pk_bf16_f32 v130, v132, v133
    v_cvt_pk_bf16_f32 v131, v134, v135
    buffer_store_dwordx4 v[128:131], v32, s[24:27], s12 offen sc1
    v_max_f32 v136, 0, v136
    v_max_f32 v137, 0, v137
    v_max_f32 v138, 0, v138
    v_max_f32 v139, 0, v139
    v_max_f32 v140, 0, v140
    v_max_f32 v141, 0, v141
    v_max_f32 v142, 0, v142
    v_max_f32 v143, 0, v143
    s_add_u32 s54, s12, 16384
    v_pk_mul_f32 v[136:137], v[136:137], v[136:137]
    v_pk_mul_f32 v[138:139], v[138:139], v[138:139]
    v_pk_mul_f32 v[140:141], v[140:141], v[140:141]
    v_pk_mul_f32 v[142:143], v[142:143], v[142:143]
    v_cvt_pk_bf16_f32 v136, v136, v137
    v_cvt_pk_bf16_f32 v137, v138, v139
    v_cvt_pk_bf16_f32 v138, v140, v141
    v_cvt_pk_bf16_f32 v139, v142, v143
    buffer_store_dwordx4 v[136:139], v32, s[24:27], s54 offen sc1
    v_max_f32 v144, 0, v144
    v_max_f32 v145, 0, v145
    v_max_f32 v146, 0, v146
    v_max_f32 v147, 0, v147
    v_max_f32 v148, 0, v148
    v_max_f32 v149, 0, v149
    v_max_f32 v150, 0, v150
    v_max_f32 v151, 0, v151
    v_pk_mul_f32 v[144:145], v[144:145], v[144:145]
    v_pk_mul_f32 v[146:147], v[146:147], v[146:147]
    v_pk_mul_f32 v[148:149], v[148:149], v[148:149]
    v_pk_mul_f32 v[150:151], v[150:151], v[150:151]
    v_cvt_pk_bf16_f32 v144, v144, v145
    v_cvt_pk_bf16_f32 v145, v146, v147
    v_cvt_pk_bf16_f32 v146, v148, v149
    v_cvt_pk_bf16_f32 v147, v150, v151
    buffer_store_dwordx4 v[144:147], v33, s[24:27], s12 offen sc1
    v_max_f32 v152, 0, v152
    v_max_f32 v153, 0, v153
    v_max_f32 v154, 0, v154
    v_max_f32 v155, 0, v155
    v_max_f32 v156, 0, v156
    v_max_f32 v157, 0, v157
    v_max_f32 v158, 0, v158
    v_max_f32 v159, 0, v159
    s_add_u32 s54, s12, 16384
    v_pk_mul_f32 v[152:153], v[152:153], v[152:153]
    v_pk_mul_f32 v[154:155], v[154:155], v[154:155]
    v_pk_mul_f32 v[156:157], v[156:157], v[156:157]
    v_pk_mul_f32 v[158:159], v[158:159], v[158:159]
    v_cvt_pk_bf16_f32 v152, v152, v153
    v_cvt_pk_bf16_f32 v153, v154, v155
    v_cvt_pk_bf16_f32 v154, v156, v157
    v_cvt_pk_bf16_f32 v155, v158, v159
    buffer_store_dwordx4 v[152:155], v33, s[24:27], s54 offen sc1
    v_max_f32 v160, 0, v160
    v_max_f32 v161, 0, v161
    v_max_f32 v162, 0, v162
    v_max_f32 v163, 0, v163
    v_max_f32 v164, 0, v164
    v_max_f32 v165, 0, v165
    v_max_f32 v166, 0, v166
    v_max_f32 v167, 0, v167
    v_pk_mul_f32 v[160:161], v[160:161], v[160:161]
    v_pk_mul_f32 v[162:163], v[162:163], v[162:163]
    v_pk_mul_f32 v[164:165], v[164:165], v[164:165]
    v_pk_mul_f32 v[166:167], v[166:167], v[166:167]
    v_cvt_pk_bf16_f32 v160, v160, v161
    v_cvt_pk_bf16_f32 v161, v162, v163
    v_cvt_pk_bf16_f32 v162, v164, v165
    v_cvt_pk_bf16_f32 v163, v166, v167
    buffer_store_dwordx4 v[160:163], v32, s[24:27], s13 offen sc1
    v_max_f32 v168, 0, v168
    v_max_f32 v169, 0, v169
    v_max_f32 v170, 0, v170
    v_max_f32 v171, 0, v171
    v_max_f32 v172, 0, v172
    v_max_f32 v173, 0, v173
    v_max_f32 v174, 0, v174
    v_max_f32 v175, 0, v175
    s_add_u32 s54, s13, 16384
    v_pk_mul_f32 v[168:169], v[168:169], v[168:169]
    v_pk_mul_f32 v[170:171], v[170:171], v[170:171]
    v_pk_mul_f32 v[172:173], v[172:173], v[172:173]
    v_pk_mul_f32 v[174:175], v[174:175], v[174:175]
    v_cvt_pk_bf16_f32 v168, v168, v169
    v_cvt_pk_bf16_f32 v169, v170, v171
    v_cvt_pk_bf16_f32 v170, v172, v173
    v_cvt_pk_bf16_f32 v171, v174, v175
    buffer_store_dwordx4 v[168:171], v32, s[24:27], s54 offen sc1
    s_mov_b32 s60, 0
    s_branch LQ_po23
LQ_ph20:
    s_waitcnt vmcnt(6)
    s_atomic_add s1, s[24:25], s58
    s_brev_b32 s60, 1
    s_branch LQ_ps19
LQ_ph22:
    s_waitcnt vmcnt(6)
    s_atomic_add s1, s[24:25], s58
    s_branch LQ_pf21
LQ_po23:
    ds_read_b64_tr_b16 v[40:41], v31 offset:256
    ds_read_b64_tr_b16 v[42:43], v31 offset:2304
    ds_read_b64_tr_b16 v[44:45], v31 offset:512
    ds_read_b64_tr_b16 v[46:47], v31 offset:2560
    ds_read_b64_tr_b16 v[48:49], v31 offset:768
    ds_read_b64_tr_b16 v[50:51], v31 offset:2816
    ds_read_b64_tr_b16 v[52:53], v31 offset:4352
    ds_read_b64_tr_b16 v[54:55], v31 offset:6400
    ds_read_b64_tr_b16 v[56:57], v31 offset:4608
    ds_read_b64_tr_b16 v[58:59], v31 offset:6656
    ds_read_b64_tr_b16 v[60:61], v31 offset:4864
    ds_read_b64_tr_b16 v[62:63], v31 offset:6912
    s_waitcnt vmcnt(28) lgkmcnt(8)
    v_mfma_f32_32x32x16_bf16 v[80:95], v[40:43], a[0:3], 0
    ds_read_b64_tr_b16 v[2:3], v31 offset:8448
    ds_read_b64_tr_b16 v[4:5], v31 offset:10496
    v_mfma_f32_32x32x16_bf16 v[96:111], v[44:47], a[0:3], 0
    ds_read_b64_tr_b16 v[6:7], v31 offset:8704
    ds_read_b64_tr_b16 v[8:9], v31 offset:10752
    buffer_load_dwordx4 v27, s[20:23], s50 offen lds
    s_add_u32 s50, s101, 376832
    s_add_u32 m0, s63, 61440
    s_waitcnt lgkmcnt(8)
    v_mfma_f32_32x32x16_bf16 v[112:127], v[48:51], a[0:3], 0
    ds_read_b64_tr_b16 v[40:41], v31 offset:8960
    ds_read_b64_tr_b16 v[42:43], v31 offset:11008
    buffer_load_dwordx4 v27, s[20:23], s50 offen lds
    s_add_u32 s50, s101, 393216
    s_add_u32 m0, s63, 114688
    s_waitcnt vmcnt(29)
    v_mfma_f32_32x32x16_bf16 v[80:95], v[52:55], a[4:7], v[80:95]
    ds_read_b64_tr_b16 v[44:45], v31 offset:12544
    ds_read_b64_tr_b16 v[46:47], v31 offset:14592
    buffer_load_dwordx4 v27, s[20:23], s50 offen lds
    s_add_u32 s50, s101, 409600
    s_add_u32 m0, s63, 118784
    s_waitcnt lgkmcnt(8)
    v_mfma_f32_32x32x16_bf16 v[96:111], v[56:59], a[4:7], v[96:111]
    ds_read_b64_tr_b16 v[48:49], v31 offset:12800
    ds_read_b64_tr_b16 v[50:51], v31 offset:14848
    v_mfma_f32_32x32x16_bf16 v[112:127], v[60:63], a[4:7], v[112:127]
    ds_read_b64_tr_b16 v[52:53], v31 offset:13056
    ds_read_b64_tr_b16 v[54:55], v31 offset:15104
    s_waitcnt vmcnt(15)
    s_barrier
    s_waitcnt lgkmcnt(8)
    v_mfma_f32_32x32x16_bf16 v[80:95], v[2:5], a[8:11], v[80:95]
    ds_read_b64_tr_b16 v[56:57], v30 offset:33024
    ds_read_b64_tr_b16 v[58:59], v30 offset:35072
    v_mfma_f32_32x32x16_bf16 v[96:111], v[6:9], a[8:11], v[96:111]
    ds_read_b64_tr_b16 v[60:61], v30 offset:33280
    ds_read_b64_tr_b16 v[62:63], v30 offset:35328
    s_waitcnt lgkmcnt(8)
    v_mfma_f32_32x32x16_bf16 v[112:127], v[40:43], a[8:11], v[112:127]
    ds_read_b64_tr_b16 v[2:3], v30 offset:33536
    ds_read_b64_tr_b16 v[4:5], v30 offset:35584
    v_mfma_f32_32x32x16_bf16 v[80:95], v[44:47], a[12:15], v[80:95]
    ds_read_b64_tr_b16 v[6:7], v30 offset:37120
    ds_read_b64_tr_b16 v[8:9], v30 offset:39168
    s_waitcnt lgkmcnt(8)
    v_mfma_f32_32x32x16_bf16 v[96:111], v[48:51], a[12:15], v[96:111]
    ds_read_b64_tr_b16 v[40:41], v30 offset:37376
    ds_read_b64_tr_b16 v[42:43], v30 offset:39424
    v_mfma_f32_32x32x16_bf16 v[112:127], v[52:55], a[12:15], v[112:127]
    ds_read_b64_tr_b16 v[44:45], v30 offset:37632
    ds_read_b64_tr_b16 v[46:47], v30 offset:39680
    buffer_load_dwordx4 v27, s[20:23], s50 offen lds
    s_add_u32 s50, s101, 425984
    s_add_u32 m0, s63, 122880
    s_waitcnt lgkmcnt(8)
    v_mfma_f32_32x32x16_bf16 v[80:95], v[56:59], a[16:19], v[80:95]
    ds_read_b64_tr_b16 v[48:49], v30 offset:41216
    ds_read_b64_tr_b16 v[50:51], v30 offset:43264
    v_mfma_f32_32x32x16_bf16 v[96:111], v[60:63], a[16:19], v[96:111]
    ds_read_b64_tr_b16 v[52:53], v30 offset:41472
    ds_read_b64_tr_b16 v[54:55], v30 offset:43520
    buffer_load_dwordx4 v27, s[20:23], s50 offen lds
    s_add_u32 s50, s101, 442368
    s_add_u32 m0, s63, 126976
    s_waitcnt lgkmcnt(8)
    v_mfma_f32_32x32x16_bf16 v[112:127], v[2:5], a[16:19], v[112:127]
    ds_read_b64_tr_b16 v[56:57], v30 offset:41728
    ds_read_b64_tr_b16 v[58:59], v30 offset:43776
    v_mfma_f32_32x32x16_bf16 v[80:95], v[6:9], a[20:23], v[80:95]
    ds_read_b64_tr_b16 v[60:61], v30 offset:45312
    ds_read_b64_tr_b16 v[62:63], v30 offset:47360
    s_waitcnt lgkmcnt(8)
    v_mfma_f32_32x32x16_bf16 v[96:111], v[40:43], a[20:23], v[96:111]
    ds_read_b64_tr_b16 v[2:3], v30 offset:45568
    ds_read_b64_tr_b16 v[4:5], v30 offset:47616
    buffer_load_dwordx4 v27, s[20:23], s50 offen lds
    s_add_u32 s50, s14, 131072
    s_add_u32 m0, s63, 81920
    v_mfma_f32_32x32x16_bf16 v[112:127], v[44:47], a[20:23], v[112:127]
    ds_read_b64_tr_b16 v[6:7], v30 offset:45824
    ds_read_b64_tr_b16 v[8:9], v30 offset:47872
    s_getreg_b32 s37, hwreg(HW_REG_IB_STS)
    s_and_b32 s37, s37, 0xc0000f
    s_or_b32 s37, s37, s60
    s_cmp_le_u32 s37, 0x6
    s_cbranch_scc1 LQ_ph20
LQ_ps19:
    s_waitcnt vmcnt(4)
    s_cmp_eq_u32 s60, 0
    s_cbranch_scc1 LQ_ph22
LQ_pf21:
    s_barrier
    s_waitcnt lgkmcnt(8)
    v_mfma_f32_32x32x16_bf16 v[80:95], v[48:51], a[24:27], v[80:95]
    ds_read_b64_tr_b16 v[40:41], v29 offset:49408
    ds_read_b64_tr_b16 v[42:43], v29 offset:51456
    buffer_load_dwordx4 v27, s[20:23], s50 offen lds
    s_add_u32 s50, s14, 147456
    s_add_u32 m0, s63, 86016
    v_mfma_f32_32x32x16_bf16 v[96:111], v[52:55], a[24:27], v[96:111]
    ds_read_b64_tr_b16 v[44:45], v29 offset:49664
    ds_read_b64_tr_b16 v[46:47], v29 offset:51712
    buffer_load_dwordx4 v27, s[20:23], s50 offen lds
    s_add_u32 s50, s14, 163840
    s_add_u32 m0, s63, 90112
    s_waitcnt lgkmcnt(8)
    v_mfma_f32_32x32x16_bf16 v[112:127], v[56:59], a[24:27], v[112:127]
    ds_read_b64_tr_b16 v[48:49], v29 offset:49920
    ds_read_b64_tr_b16 v[50:51], v29 offset:51968
    buffer_load_dwordx4 v27, s[20:23], s50 offen lds
    s_add_u32 s50, s14, 180224
    s_add_u32 m0, s63, 94208
    v_mfma_f32_32x32x16_bf16 v[80:95], v[60:63], a[28:31], v[80:95]
    ds_read_b64_tr_b16 v[52:53], v29 offset:53504
    ds_read_b64_tr_b16 v[54:55], v29 offset:55552
    buffer_load_dwordx4 v27, s[20:23], s50 offen lds
    s_add_u32 s50, s14, 196608
    s_add_u32 m0, s63, 32768
    s_waitcnt lgkmcnt(8)
    v_mfma_f32_32x32x16_bf16 v[96:111], v[2:5], a[28:31], v[96:111]
    ds_read_b64_tr_b16 v[56:57], v29 offset:53760
    ds_read_b64_tr_b16 v[58:59], v29 offset:55808
    buffer_load_dwordx4 v27, s[20:23], s50 offen lds
    s_add_u32 s50, s14, 212992
    s_add_u32 m0, s63, 36864
    v_mfma_f32_32x32x16_bf16 v[112:127], v[6:9], a[28:31], v[112:127]
    ds_read_b64_tr_b16 v[60:61], v29 offset:54016
    ds_read_b64_tr_b16 v[62:63], v29 offset:56064
    buffer_load_dwordx4 v27, s[20:23], s50 offen lds
    s_add_u32 s50, s56, 229376
    s_add_u32 m0, s63, 40960
    s_waitcnt lgkmcnt(8)
    v_mfma_f32_32x32x16_bf16 v[80:95], v[40:43], a[32:35], v[80:95]
    ds_read_b64_tr_b16 v[2:3], v29 offset:57600
    ds_read_b64_tr_b16 v[4:5], v29 offset:59648
    buffer_load_dwordx4 v27, s[20:23], s50 offen lds
    s_add_u32 s50, s56, 245760
    s_add_u32 m0, s63, 45056
    v_mfma_f32_32x32x16_bf16 v[96:111], v[44:47], a[32:35], v[96:111]
    ds_read_b64_tr_b16 v[6:7], v29 offset:57856
    ds_read_b64_tr_b16 v[8:9], v29 offset:59904
    buffer_load_dwordx4 v27, s[20:23], s50 offen lds
    s_add_u32 s50, s56, 262144
    s_add_u32 m0, s63, 0
    s_waitcnt lgkmcnt(8)
    v_mfma_f32_32x32x16_bf16 v[112:127], v[48:51], a[32:35], v[112:127]
    ds_read_b64_tr_b16 v[40:41], v29 offset:58112
    ds_read_b64_tr_b16 v[42:43], v29 offset:60160
    buffer_load_dwordx4 v27, s[20:23], s50 offen lds
    s_add_u32 s50, s56, 278528
    s_add_u32 m0, s63, 4096
    v_mfma_f32_32x32x16_bf16 v[80:95], v[52:55], a[36:39], v[80:95]
    ds_read_b64_tr_b16 v[44:45], v29 offset:61696
    ds_read_b64_tr_b16 v[46:47], v29 offset:63744
    s_waitcnt lgkmcnt(8)
    v_mfma_f32_32x32x16_bf16 v[96:111], v[56:59], a[36:39], v[96:111]
    ds_read_b64_tr_b16 v[48:49], v29 offset:61952
    ds_read_b64_tr_b16 v[50:51], v29 offset:64000
    v_mfma_f32_32x32x16_bf16 v[112:127], v[60:63], a[36:39], v[112:127]
    ds_read_b64_tr_b16 v[52:53], v29 offset:62208
    ds_read_b64_tr_b16 v[54:55], v29 offset:64256
    s_waitcnt vmcnt(9)
    s_barrier
    s_waitcnt lgkmcnt(8)
    v_mfma_f32_32x32x16_bf16 v[80:95], v[2:5], a[40:43], v[80:95]
    ds_read_b64_tr_b16 v[56:57], v30 offset:49408
    ds_read_b64_tr_b16 v[58:59], v30 offset:51456
    v_mfma_f32_32x32x16_bf16 v[96:111], v[6:9], a[40:43], v[96:111]
    ds_read_b64_tr_b16 v[60:61], v30 offset:49664
    ds_read_b64_tr_b16 v[62:63], v30 offset:51712
    s_waitcnt lgkmcnt(8)
    v_mfma_f32_32x32x16_bf16 v[112:127], v[40:43], a[40:43], v[112:127]
    ds_read_b64_tr_b16 v[2:3], v30 offset:49920
    ds_read_b64_tr_b16 v[4:5], v30 offset:51968
    v_mfma_f32_32x32x16_bf16 v[80:95], v[44:47], a[44:47], v[80:95]
    ds_read_b64_tr_b16 v[6:7], v30 offset:53504
    ds_read_b64_tr_b16 v[8:9], v30 offset:55552
    s_waitcnt lgkmcnt(8)
    v_mfma_f32_32x32x16_bf16 v[96:111], v[48:51], a[44:47], v[96:111]
    ds_read_b64_tr_b16 v[40:41], v30 offset:53760
    ds_read_b64_tr_b16 v[42:43], v30 offset:55808
    v_mfma_f32_32x32x16_bf16 v[112:127], v[52:55], a[44:47], v[112:127]
    ds_read_b64_tr_b16 v[44:45], v30 offset:54016
    ds_read_b64_tr_b16 v[46:47], v30 offset:56064
    s_waitcnt lgkmcnt(8)
    v_mfma_f32_32x32x16_bf16 v[80:95], v[56:59], a[48:51], v[80:95]
    ds_read_b64_tr_b16 v[48:49], v30 offset:57600
    ds_read_b64_tr_b16 v[50:51], v30 offset:59648
    v_mfma_f32_32x32x16_bf16 v[96:111], v[60:63], a[48:51], v[96:111]
    ds_read_b64_tr_b16 v[52:53], v30 offset:57856
    ds_read_b64_tr_b16 v[54:55], v30 offset:59904
    buffer_load_dwordx4 v27, s[20:23], s50 offen lds
    s_add_u32 s50, s56, 294912
    s_add_u32 m0, s63, 8192
    s_waitcnt lgkmcnt(8)
    v_mfma_f32_32x32x16_bf16 v[112:127], v[2:5], a[48:51], v[112:127]
    ds_read_b64_tr_b16 v[56:57], v30 offset:58112
    ds_read_b64_tr_b16 v[58:59], v30 offset:60160
    v_mfma_f32_32x32x16_bf16 v[80:95], v[6:9], a[52:55], v[80:95]
    ds_read_b64_tr_b16 v[60:61], v30 offset:61696
    ds_read_b64_tr_b16 v[62:63], v30 offset:63744
    buffer_load_dwordx4 v27, s[20:23], s50 offen lds
    s_add_u32 s50, s56, 311296
    s_add_u32 m0, s63, 12288
    s_barrier
    buffer_load_dwordx4 v27, s[20:23], s50 offen lds
    s_add_u32 s53, s14, 131072
    buffer_load_dwordx4 a[64:67], v32, s[24:27], s53 offen sc1
    s_add_u32 s53, s14, 147456
    buffer_load_dwordx4 a[68:71], v32, s[24:27], s53 offen sc1
    s_add_u32 s53, s14, 163840
    s_waitcnt lgkmcnt(8)
    v_mfma_f32_32x32x16_bf16 v[96:111], v[40:43], a[52:55], v[96:111]
    ds_read_b64_tr_b16 v[2:3], v30 offset:61952
    ds_read_b64_tr_b16 v[4:5], v30 offset:64000
    v_mfma_f32_32x32x16_bf16 v[112:127], v[44:47], a[52:55], v[112:127]
    ds_read_b64_tr_b16 v[6:7], v30 offset:62208
    ds_read_b64_tr_b16 v[8:9], v30 offset:64256
    s_atomic_umax s96, s[24:25], s58 glc
    s_mov_b32 s36, 0
    s_atomic_umax s36, s[24:25], s15 glc
    s_waitcnt lgkmcnt(8)
    v_mfma_f32_32x32x16_bf16 v[80:95], v[48:51], a[56:59], v[80:95]
    ds_read_b64_tr_b16 v[40:41], v31 offset:0
    ds_read_b64_tr_b16 v[42:43], v31 offset:2048
    v_mfma_f32_32x32x16_bf16 v[96:111], v[52:55], a[56:59], v[96:111]
    ds_read_b64_tr_b16 v[44:45], v31 offset:4096
    ds_read_b64_tr_b16 v[46:47], v31 offset:6144
    s_waitcnt lgkmcnt(8)
    v_mfma_f32_32x32x16_bf16 v[112:127], v[56:59], a[56:59], v[112:127]
    ds_read_b64_tr_b16 v[48:49], v31 offset:8192
    ds_read_b64_tr_b16 v[50:51], v31 offset:10240
    v_mfma_f32_32x32x16_bf16 v[80:95], v[60:63], a[60:63], v[80:95]
    ds_read_b64_tr_b16 v[52:53], v31 offset:12288
    ds_read_b64_tr_b16 v[54:55], v31 offset:14336
    s_waitcnt lgkmcnt(8)
    v_mfma_f32_32x32x16_bf16 v[96:111], v[2:5], a[60:63], v[96:111]
    ds_read_b64_tr_b16 v[56:57], v30 offset:32768
    ds_read_b64_tr_b16 v[58:59], v30 offset:34816
    buffer_load_dwordx4 a[72:75], v32, s[24:27], s53 offen sc1
    s_add_u32 s53, s14, 180224
    v_mfma_f32_32x32x16_bf16 v[112:127], v[6:9], a[60:63], v[112:127]
    ds_read_b64_tr_b16 v[60:61], v30 offset:36864
    ds_read_b64_tr_b16 v[62:63], v30 offset:38912
    s_waitcnt lgkmcnt(8)
    v_mfma_f32_32x32x16_bf16 v[64:79], v[40:43], a[0:3], 0
    ds_read_b64_tr_b16 v[2:3], v30 offset:40960
    ds_read_b64_tr_b16 v[4:5], v30 offset:43008
    v_mfma_f32_32x32x16_bf16 v[64:79], v[44:47], a[4:7], v[64:79]
    ds_read_b64_tr_b16 v[6:7], v30 offset:45056
    ds_read_b64_tr_b16 v[8:9], v30 offset:47104
    buffer_load_dwordx4 a[76:79], v32, s[24:27], s53 offen sc1
    s_add_u32 s53, s14, 196608
    s_waitcnt lgkmcnt(8)
    v_mfma_f32_32x32x16_bf16 v[64:79], v[48:51], a[8:11], v[64:79]
    ds_read_b64_tr_b16 v[40:41], v29 offset:49152
    ds_read_b64_tr_b16 v[42:43], v29 offset:51200
    v_mfma_f32_32x32x16_bf16 v[64:79], v[52:55], a[12:15], v[64:79]
    ds_read_b64_tr_b16 v[44:45], v29 offset:53248
    ds_read_b64_tr_b16 v[46:47], v29 offset:55296
    buffer_load_dwordx4 a[80:83], v32, s[24:27], s53 offen sc1
    s_add_u32 s53, s14, 212992
    s_waitcnt vmcnt(9)
    s_barrier
    s_waitcnt lgkmcnt(8)
    v_mfma_f32_32x32x16_bf16 v[64:79], v[56:59], a[16:19], v[64:79]
    ds_read_b64_tr_b16 v[48:49], v30 offset:16640
    ds_read_b64_tr_b16 v[50:51], v30 offset:18688
    v_mfma_f32_32x32x16_bf16 v[64:79], v[60:63], a[20:23], v[64:79]
    ds_read_b64_tr_b16 v[52:53], v30 offset:16896
    ds_read_b64_tr_b16 v[54:55], v30 offset:18944
    buffer_load_dwordx4 a[84:87], v32, s[24:27], s53 offen sc1
    s_add_u32 s50, s57, 0
    s_add_u32 m0, s63, 65536
    s_waitcnt lgkmcnt(8)
    v_mfma_f32_32x32x16_bf16 v[64:79], v[2:5], a[24:27], v[64:79]
    ds_read_b64_tr_b16 v[56:57], v30 offset:17152
    ds_read_b64_tr_b16 v[58:59], v30 offset:19200
    v_mfma_f32_32x32x16_bf16 v[64:79], v[6:9], a[28:31], v[64:79]
    ds_read_b64_tr_b16 v[60:61], v30 offset:20736
    ds_read_b64_tr_b16 v[62:63], v30 offset:22784
    buffer_load_dwordx4 v27, s[16:19], s50 offen lds
    s_add_u32 s50, s57, 16384
    s_add_u32 m0, s63, 69632
    s_waitcnt lgkmcnt(8)
    v_mfma_f32_32x32x16_bf16 v[64:79], v[40:43], a[32:35], v[64:79]
    ds_read_b64_tr_b16 v[2:3], v30 offset:20992
    ds_read_b64_tr_b16 v[4:5], v30 offset:23040
    v_mfma_f32_32x32x16_bf16 v[64:79], v[44:47], a[36:39], v[64:79]
    ds_read_b64_tr_b16 v[6:7], v30 offset:21248
    ds_read_b64_tr_b16 v[8:9], v30 offset:23296
    s_bfe_u32 s37, s96, 0x80008
    s_cmp_ge_u32 s37, 4
    s_cbranch_scc0 LQ_g24
    s_bfe_u32 s37, s36, 0x80000
    s_cmp_ge_u32 s37, 16
    s_cbranch_scc1 LQ_gd25
LQ_g24:
    s_waitcnt lgkmcnt(0)
    s_bfe_u32 s37, s96, 0x80008
    s_cmp_ge_u32 s37, 4
    s_cbranch_scc0 LQ_ga26
    s_bfe_u32 s37, s36, 0x80000
    s_cmp_ge_u32 s37, 16
    s_cbranch_scc1 LQ_gd25
LQ_ga26:
    s_cmp_eq_u32 s98, 0
    s_cbranch_scc1 LQ_gd25
    s_sub_u32 s98, s98, 1
    s_atomic_umax s96, s[24:25], s58 glc
    s_atomic_umax s36, s[24:25], s15 glc
    s_branch LQ_g24
LQ_gd25:
    s_lshl_b32 s37, s45, 2
    s_add_u32 s37, s37, s42
    s_lshl_b32 s37, s37, 7
    s_add_u32 s37, s37, 0x9e0000
    buffer_load_dword v246, v35, s[24:27], s37 offen sc1
    buffer_load_dwordx4 v27, s[16:19], s50 offen lds
    s_add_u32 s53, s56, 229376
    buffer_load_dwordx4 a[88:91], v32, s[24:27], s53 offen sc1
    s_add_u32 s53, s56, 245760
    s_waitcnt vmcnt(9) lgkmcnt(8)
    v_mfma_f32_32x32x16_bf16 v[80:95], v[48:51], a[64:67], v[80:95]
    ds_read_b64_tr_b16 v[40:41], v30 offset:24832
    ds_read_b64_tr_b16 v[42:43], v30 offset:26880
    v_mfma_f32_32x32x16_bf16 v[96:111], v[52:55], a[64:67], v[96:111]
    ds_read_b64_tr_b16 v[44:45], v30 offset:25088
    ds_read_b64_tr_b16 v[46:47], v30 offset:27136
    s_waitcnt lgkmcnt(8)
    v_mfma_f32_32x32x16_bf16 v[112:127], v[56:59], a[64:67], v[112:127]
    ds_read_b64_tr_b16 v[48:49], v30 offset:25344
    ds_read_b64_tr_b16 v[50:51], v30 offset:27392
    buffer_load_dwordx4 a[92:95], v32, s[24:27], s53 offen sc1
    s_add_u32 s53, s56, 262144
    s_waitcnt vmcnt(9)
    v_mfma_f32_32x32x16_bf16 v[80:95], v[60:63], a[68:71], v[80:95]
    ds_read_b64_tr_b16 v[52:53], v30 offset:28928
    ds_read_b64_tr_b16 v[54:55], v30 offset:30976
    s_waitcnt lgkmcnt(8)
    v_mfma_f32_32x32x16_bf16 v[96:111], v[2:5], a[68:71], v[96:111]
    ds_read_b64_tr_b16 v[56:57], v30 offset:29184
    ds_read_b64_tr_b16 v[58:59], v30 offset:31232
    buffer_load_dwordx4 a[96:99], v32, s[24:27], s53 offen sc1
    s_add_u32 s53, s56, 278528
    v_mfma_f32_32x32x16_bf16 v[112:127], v[6:9], a[68:71], v[112:127]
    ds_read_b64_tr_b16 v[60:61], v30 offset:29440
    ds_read_b64_tr_b16 v[62:63], v30 offset:31488
    s_waitcnt vmcnt(9) lgkmcnt(8)
    v_mfma_f32_32x32x16_bf16 v[80:95], v[40:43], a[72:75], v[80:95]
    ds_read_b64_tr_b16 v[2:3], v29 offset:33024
    ds_read_b64_tr_b16 v[4:5], v29 offset:35072
    v_mfma_f32_32x32x16_bf16 v[96:111], v[44:47], a[72:75], v[96:111]
    ds_read_b64_tr_b16 v[6:7], v29 offset:33280
    ds_read_b64_tr_b16 v[8:9], v29 offset:35328
    buffer_load_dwordx4 a[100:103], v32, s[24:27], s53 offen sc1
    s_add_u32 s53, s56, 294912
    s_waitcnt lgkmcnt(8)
    v_mfma_f32_32x32x16_bf16 v[112:127], v[48:51], a[72:75], v[112:127]
    ds_read_b64_tr_b16 v[40:41], v29 offset:33536
    ds_read_b64_tr_b16 v[42:43], v29 offset:35584
    s_waitcnt vmcnt(9)
    v_mfma_f32_32x32x16_bf16 v[80:95], v[52:55], a[76:79], v[80:95]
    ds_read_b64_tr_b16 v[44:45], v29 offset:37120
    ds_read_b64_tr_b16 v[46:47], v29 offset:39168
    buffer_load_dwordx4 a[104:107], v32, s[24:27], s53 offen sc1
    s_add_u32 s53, s56, 311296
    s_atomic_umax s96, s[24:25], s58 glc
    s_waitcnt lgkmcnt(8)
    v_mfma_f32_32x32x16_bf16 v[96:111], v[56:59], a[76:79], v[96:111]
    ds_read_b64_tr_b16 v[48:49], v29 offset:37376
    ds_read_b64_tr_b16 v[50:51], v29 offset:39424
    v_mfma_f32_32x32x16_bf16 v[112:127], v[60:63], a[76:79], v[112:127]
    ds_read_b64_tr_b16 v[52:53], v29 offset:37632
    ds_read_b64_tr_b16 v[54:55], v29 offset:39680
    buffer_load_dwordx4 a[108:111], v32, s[24:27], s53 offen sc1
    s_add_u32 s50, s57, 32768
    s_add_u32 m0, s63, 73728
    s_waitcnt vmcnt(10) lgkmcnt(8)
    v_mfma_f32_32x32x16_bf16 v[80:95], v[2:5], a[80:83], v[80:95]
    ds_read_b64_tr_b16 v[56:57], v29 offset:41216
    ds_read_b64_tr_b16 v[58:59], v29 offset:43264
    v_mfma_f32_32x32x16_bf16 v[96:111], v[6:9], a[80:83], v[96:111]
    ds_read_b64_tr_b16 v[60:61], v29 offset:41472
    ds_read_b64_tr_b16 v[62:63], v29 offset:43520
    buffer_load_dwordx4 v27, s[16:19], s50 offen lds
    s_add_u32 s50, s57, 49152
    s_add_u32 m0, s63, 77824
    s_waitcnt lgkmcnt(8)
    v_mfma_f32_32x32x16_bf16 v[112:127], v[40:43], a[80:83], v[112:127]
    ds_read_b64_tr_b16 v[2:3], v29 offset:41728
    ds_read_b64_tr_b16 v[4:5], v29 offset:43776
    s_waitcnt vmcnt(10)
    v_mfma_f32_32x32x16_bf16 v[80:95], v[44:47], a[84:87], v[80:95]
    ds_read_b64_tr_b16 v[6:7], v29 offset:45312
    ds_read_b64_tr_b16 v[8:9], v29 offset:47360
    buffer_load_dwordx4 v27, s[16:19], s50 offen lds
    s_add_u32 s50, s57, 65536
    s_add_u32 m0, s63, 16384
    s_waitcnt lgkmcnt(8)
    v_mfma_f32_32x32x16_bf16 v[96:111], v[48:51], a[84:87], v[96:111]
    ds_read_b64_tr_b16 v[40:41], v29 offset:45568
    ds_read_b64_tr_b16 v[42:43], v29 offset:47616
    v_mfma_f32_32x32x16_bf16 v[112:127], v[52:55], a[84:87], v[112:127]
    ds_read_b64_tr_b16 v[44:45], v29 offset:45824
    ds_read_b64_tr_b16 v[46:47], v29 offset:47872
    buffer_load_dwordx4 v27, s[16:19], s50 offen lds
    s_add_u32 s50, s57, 81920
    s_add_u32 m0, s63, 20480
    s_barrier
    s_waitcnt vmcnt(8) lgkmcnt(8)
    v_mfma_f32_32x32x16_bf16 v[80:95], v[56:59], a[88:91], v[80:95]
    ds_read_b64_tr_b16 v[48:49], v29 offset:256
    ds_read_b64_tr_b16 v[50:51], v29 offset:2304
    buffer_load_dwordx4 v27, s[16:19], s50 offen lds
    s_add_u32 s50, s57, 98304
    s_add_u32 m0, s63, 24576
    v_sub_f32 v244, 1.0, v246
    v_mfma_f32_32x32x16_bf16 v[96:111], v[60:63], a[88:91], v[96:111]
    ds_read_b64_tr_b16 v[52:53], v29 offset:512
    ds_read_b64_tr_b16 v[54:55], v29 offset:2560
    v_cvt_pk_bf16_f32 v244, v244, v244
    v_lshlrev_b32 v244, 16, v244
    v_lshlrev_b32 v228, 16, v10
    s_waitcnt lgkmcnt(8)
    v_mfma_f32_32x32x16_bf16 v[112:127], v[2:5], a[88:91], v[112:127]
    ds_read_b64_tr_b16 v[56:57], v29 offset:768
    ds_read_b64_tr_b16 v[58:59], v29 offset:2816
    buffer_load_dwordx4 v27, s[16:19], s50 offen lds
    s_add_u32 s50, s57, 114688
    s_add_u32 m0, s63, 28672
    v_and_b32 v229, v254, v10
    s_waitcnt vmcnt(9)
    v_mfma_f32_32x32x16_bf16 v[80:95], v[6:9], a[92:95], v[80:95]
    ds_read_b64_tr_b16 v[60:61], v29 offset:4352
    ds_read_b64_tr_b16 v[62:63], v29 offset:6400
    v_lshlrev_b32 v230, 16, v11
    v_and_b32 v231, v254, v11
    v_lshlrev_b32 v232, 16, v12
    v_and_b32 v233, v254, v12
    s_waitcnt lgkmcnt(8)
    v_mfma_f32_32x32x16_bf16 v[96:111], v[40:43], a[92:95], v[96:111]
    ds_read_b64_tr_b16 v[2:3], v29 offset:4608
    ds_read_b64_tr_b16 v[4:5], v29 offset:6656
    buffer_load_dwordx4 v27, s[16:19], s50 offen lds
    v_lshlrev_b32 v234, 16, v13
    v_and_b32 v235, v254, v13
    v_lshlrev_b32 v236, 16, v14
    v_mfma_f32_32x32x16_bf16 v[112:127], v[44:47], a[92:95], v[112:127]
    ds_read_b64_tr_b16 v[6:7], v29 offset:4864
    ds_read_b64_tr_b16 v[8:9], v29 offset:6912
    v_and_b32 v237, v254, v14
    v_lshlrev_b32 v238, 16, v15
    v_and_b32 v239, v254, v15
    v_lshlrev_b32 v240, 16, v16
    s_bfe_u32 s37, s96, 0x80010
    s_cmp_ge_u32 s37, 4
    s_cbranch_scc1 LQ_gd28
LQ_g27:
    s_waitcnt lgkmcnt(0)
    s_bfe_u32 s37, s96, 0x80010
    s_cmp_ge_u32 s37, 4
    s_cbranch_scc1 LQ_gd28
LQ_ga29:
    s_cmp_eq_u32 s98, 0
    s_cbranch_scc1 LQ_gd28
    s_sub_u32 s98, s98, 1
    s_atomic_umax s96, s[24:25], s58 glc
    s_branch LQ_g27
LQ_gd28:
    s_add_u32 s53, s57, 1835008
    buffer_load_dwordx4 v[196:199], v32, s[24:27], s53 offen sc1
    s_add_u32 s53, s57, 1851392
    buffer_load_dwordx4 v[200:203], v32, s[24:27], s53 offen sc1
    s_add_u32 s53, s57, 1867776
    buffer_load_dwordx4 v[204:207], v32, s[24:27], s53 offen sc1
    s_add_u32 s53, s57, 1884160
    buffer_load_dwordx4 v[208:211], v32, s[24:27], s53 offen sc1
    s_add_u32 s53, s57, 1900544
    buffer_load_dwordx4 v[212:215], v32, s[24:27], s53 offen sc1
    s_add_u32 s53, s57, 1916928
    buffer_load_dwordx4 v[216:219], v32, s[24:27], s53 offen sc1
    s_add_u32 s53, s57, 1933312
    buffer_load_dwordx4 v[220:223], v32, s[24:27], s53 offen sc1
    s_add_u32 s53, s57, 1949696
    buffer_load_dwordx4 v[224:227], v32, s[24:27], s53 offen sc1
    s_waitcnt vmcnt(17) lgkmcnt(8)
    v_mfma_f32_32x32x16_bf16 v[80:95], v[48:51], a[96:99], v[80:95]
    ds_read_b64_tr_b16 v[40:41], v29 offset:8448
    ds_read_b64_tr_b16 v[42:43], v29 offset:10496
    v_and_b32 v241, v254, v16
    v_lshlrev_b32 v242, 16, v17
    v_and_b32 v243, v254, v17
    v_mfma_f32_32x32x16_bf16 v[96:111], v[52:55], a[96:99], v[96:111]
    ds_read_b64_tr_b16 v[44:45], v29 offset:8704
    ds_read_b64_tr_b16 v[46:47], v29 offset:10752
    s_waitcnt lgkmcnt(8)
    v_mfma_f32_32x32x16_bf16 v[112:127], v[56:59], a[96:99], v[112:127]
    ds_read_b64_tr_b16 v[48:49], v29 offset:8960
    ds_read_b64_tr_b16 v[50:51], v29 offset:11008
    s_waitcnt vmcnt(16)
    v_mfma_f32_32x32x16_bf16 v[80:95], v[60:63], a[100:103], v[80:95]
    ds_read_b64_tr_b16 v[52:53], v29 offset:12544
    ds_read_b64_tr_b16 v[54:55], v29 offset:14592
    s_waitcnt lgkmcnt(8)
    v_mfma_f32_32x32x16_bf16 v[96:111], v[2:5], a[100:103], v[96:111]
    ds_read_b64_tr_b16 v[56:57], v29 offset:12800
    ds_read_b64_tr_b16 v[58:59], v29 offset:14848
    v_mfma_f32_32x32x16_bf16 v[112:127], v[6:9], a[100:103], v[112:127]
    ds_read_b64_tr_b16 v[60:61], v29 offset:13056
    ds_read_b64_tr_b16 v[62:63], v29 offset:15104
    s_waitcnt vmcnt(15) lgkmcnt(8)
    v_mfma_f32_32x32x16_bf16 v[80:95], v[40:43], a[104:107], v[80:95]
    ds_read_b64_tr_b16 v[2:3], v29 offset:57344
    ds_read_b64_tr_b16 v[4:5], v29 offset:59392
    v_mfma_f32_32x32x16_bf16 v[96:111], v[44:47], a[104:107], v[96:111]
    ds_read_b64_tr_b16 v[6:7], v29 offset:61440
    ds_read_b64_tr_b16 v[8:9], v29 offset:63488
    s_waitcnt lgkmcnt(8)
    v_mfma_f32_32x32x16_bf16 v[112:127], v[48:51], a[104:107], v[112:127]
    ds_read_b64_tr_b16 v[40:41], v30 offset:49152
    ds_read_b64_tr_b16 v[42:43], v30 offset:51200
    s_waitcnt vmcnt(14)
    v_mfma_f32_32x32x16_bf16 v[80:95], v[52:55], a[108:111], v[80:95]
    ds_read_b64_tr_b16 v[44:45], v30 offset:53248
    ds_read_b64_tr_b16 v[46:47], v30 offset:55296
    s_waitcnt lgkmcnt(8)
    v_mfma_f32_32x32x16_bf16 v[96:111], v[56:59], a[108:111], v[96:111]
    ds_read_b64_tr_b16 v[48:49], v30 offset:57344
    ds_read_b64_tr_b16 v[50:51], v30 offset:59392
    v_mfma_f32_32x32x16_bf16 v[112:127], v[60:63], a[108:111], v[112:127]
    ds_read_b64_tr_b16 v[52:53], v30 offset:61440
    ds_read_b64_tr_b16 v[54:55], v30 offset:63488
    s_waitcnt vmcnt(8)
    s_barrier
    s_waitcnt lgkmcnt(8)
    v_mfma_f32_32x32x16_bf16 v[64:79], v[2:5], a[40:43], v[64:79]
    ds_read_b64_tr_b16 v[56:57], v30 offset:256
    ds_read_b64_tr_b16 v[58:59], v30 offset:2304
    v_mfma_f32_32x32x16_bf16 v[64:79], v[6:9], a[44:47], v[64:79]
    ds_read_b64_tr_b16 v[60:61], v30 offset:4352
    ds_read_b64_tr_b16 v[62:63], v30 offset:6400
    v_mul_f32 v80, v244, v80
    v_mul_f32 v81, v244, v81
    v_mul_f32 v82, v244, v82
    v_mul_f32 v83, v244, v83
    s_waitcnt lgkmcnt(8)
    v_mfma_f32_32x32x16_bf16 v[64:79], v[40:43], a[48:51], v[64:79]
    ds_read_b64_tr_b16 v[2:3], v30 offset:8448
    ds_read_b64_tr_b16 v[4:5], v30 offset:10496
    v_mul_f32 v84, v244, v84
    v_mul_f32 v85, v244, v85
    v_mul_f32 v86, v244, v86
    v_mul_f32 v87, v244, v87
    v_mfma_f32_32x32x16_bf16 v[64:79], v[44:47], a[52:55], v[64:79]
    ds_read_b64_tr_b16 v[6:7], v30 offset:12544
    ds_read_b64_tr_b16 v[8:9], v30 offset:14592
    v_mul_f32 v88, v244, v88
    v_mul_f32 v89, v244, v89
    v_mul_f32 v90, v244, v90
    v_mul_f32 v91, v244, v91
    s_waitcnt lgkmcnt(8)
    v_mfma_f32_32x32x16_bf16 v[64:79], v[48:51], a[56:59], v[64:79]
    ds_read_b64_tr_b16 v[40:41], v29 offset:16640
    ds_read_b64_tr_b16 v[42:43], v29 offset:18688
    v_mul_f32 v92, v244, v92
    v_mul_f32 v93, v244, v93
    v_mul_f32 v94, v244, v94
    v_mul_f32 v95, v244, v95
    v_mfma_f32_32x32x16_bf16 v[64:79], v[52:55], a[60:63], v[64:79]
    ds_read_b64_tr_b16 v[44:45], v29 offset:20736
    ds_read_b64_tr_b16 v[46:47], v29 offset:22784
    v_mul_f32 v96, v244, v96
    v_mul_f32 v97, v244, v97
    v_mul_f32 v98, v244, v98
    v_mul_f32 v99, v244, v99
    s_waitcnt vmcnt(7) lgkmcnt(8)
    v_mfma_f32_32x32x16_bf16 v[80:95], v[56:59], v[196:199], v[80:95]
    ds_read_b64_tr_b16 v[48:49], v29 offset:24832
    ds_read_b64_tr_b16 v[50:51], v29 offset:26880
    v_mul_f32 v100, v244, v100
    v_mul_f32 v101, v244, v101
    v_mul_f32 v102, v244, v102
    v_mul_f32 v103, v244, v103
    v_mul_f32 v104, v244, v104
    v_mul_f32 v105, v244, v105
    s_waitcnt vmcnt(6)
    v_mfma_f32_32x32x16_bf16 v[80:95], v[60:63], v[200:203], v[80:95]
    ds_read_b64_tr_b16 v[52:53], v29 offset:28928
    ds_read_b64_tr_b16 v[54:55], v29 offset:30976
    v_mul_f32 v106, v244, v106
    v_mul_f32 v107, v244, v107
    v_mul_f32 v108, v244, v108
    v_mul_f32 v109, v244, v109
    v_mul_f32 v110, v244, v110
    v_mul_f32 v111, v244, v111
    s_waitcnt vmcnt(5) lgkmcnt(8)
    v_mfma_f32_32x32x16_bf16 v[80:95], v[2:5], v[204:207], v[80:95]
    ds_read_b64_tr_b16 v[56:57], v30 offset:512
    ds_read_b64_tr_b16 v[58:59], v30 offset:2560
    v_mul_f32 v112, v244, v112
    v_mul_f32 v113, v244, v113
    v_mul_f32 v114, v244, v114
    v_mul_f32 v115, v244, v115
    v_mul_f32 v116, v244, v116
    v_mul_f32 v117, v244, v117
    s_waitcnt vmcnt(4)
    v_mfma_f32_32x32x16_bf16 v[80:95], v[6:9], v[208:211], v[80:95]
    ds_read_b64_tr_b16 v[60:61], v30 offset:4608
    ds_read_b64_tr_b16 v[62:63], v30 offset:6656
    v_mul_f32 v118, v244, v118
    v_mul_f32 v119, v244, v119
    v_mul_f32 v120, v244, v120
    v_mul_f32 v121, v244, v121
    v_mul_f32 v122, v244, v122
    v_mul_f32 v123, v244, v123
    s_waitcnt vmcnt(3) lgkmcnt(8)
    v_mfma_f32_32x32x16_bf16 v[80:95], v[40:43], v[212:215], v[80:95]
    ds_read_b64_tr_b16 v[2:3], v30 offset:8704
    ds_read_b64_tr_b16 v[4:5], v30 offset:10752
    v_mul_f32 v124, v244, v124
    v_mul_f32 v125, v244, v125
    v_mul_f32 v126, v244, v126
    v_mul_f32 v127, v244, v127
    s_waitcnt vmcnt(2)
    v_mfma_f32_32x32x16_bf16 v[80:95], v[44:47], v[216:219], v[80:95]
    ds_read_b64_tr_b16 v[6:7], v30 offset:12800
    ds_read_b64_tr_b16 v[8:9], v30 offset:14848
    s_waitcnt vmcnt(1) lgkmcnt(8)
    v_mfma_f32_32x32x16_bf16 v[80:95], v[48:51], v[220:223], v[80:95]
    ds_read_b64_tr_b16 v[40:41], v29 offset:16896
    ds_read_b64_tr_b16 v[42:43], v29 offset:18944
    s_waitcnt vmcnt(0)
    v_mfma_f32_32x32x16_bf16 v[80:95], v[52:55], v[224:227], v[80:95]
    ds_read_b64_tr_b16 v[44:45], v29 offset:20992
    ds_read_b64_tr_b16 v[46:47], v29 offset:23040
    s_waitcnt lgkmcnt(8)
    v_mfma_f32_32x32x16_bf16 v[96:111], v[56:59], v[196:199], v[96:111]
    ds_read_b64_tr_b16 v[48:49], v29 offset:25088
    ds_read_b64_tr_b16 v[50:51], v29 offset:27136
    v_mfma_f32_32x32x16_bf16 v[96:111], v[60:63], v[200:203], v[96:111]
    ds_read_b64_tr_b16 v[52:53], v29 offset:29184
    ds_read_b64_tr_b16 v[54:55], v29 offset:31232
    s_nop 2
    v_cvt_pk_bf16_f32 v80, v80, v81
    v_cvt_pk_bf16_f32 v81, v82, v83
    v_cvt_pk_bf16_f32 v82, v84, v85
    v_cvt_pk_bf16_f32 v83, v86, v87
    buffer_store_dwordx4 v[80:83], v34, s[24:27], s4 offen offset:0 sc1
    s_waitcnt lgkmcnt(8)
    v_mfma_f32_32x32x16_bf16 v[96:111], v[2:5], v[204:207], v[96:111]
    ds_read_b64_tr_b16 v[56:57], v30 offset:768
    ds_read_b64_tr_b16 v[58:59], v30 offset:2816
    v_cvt_pk_bf16_f32 v84, v88, v89
    v_cvt_pk_bf16_f32 v85, v90, v91
    v_cvt_pk_bf16_f32 v86, v92, v93
    v_cvt_pk_bf16_f32 v87, v94, v95
    buffer_store_dwordx4 v[84:87], v34, s[24:27], s4 offen offset:1024 sc1
    v_mfma_f32_32x32x16_bf16 v[96:111], v[6:9], v[208:211], v[96:111]
    ds_read_b64_tr_b16 v[60:61], v30 offset:4864
    ds_read_b64_tr_b16 v[62:63], v30 offset:6912
    s_waitcnt lgkmcnt(8)
    v_mfma_f32_32x32x16_bf16 v[96:111], v[40:43], v[212:215], v[96:111]
    ds_read_b64_tr_b16 v[2:3], v30 offset:8960
    ds_read_b64_tr_b16 v[4:5], v30 offset:11008
    v_mfma_f32_32x32x16_bf16 v[96:111], v[44:47], v[216:219], v[96:111]
    ds_read_b64_tr_b16 v[6:7], v30 offset:13056
    ds_read_b64_tr_b16 v[8:9], v30 offset:15104
    s_waitcnt lgkmcnt(8)
    v_mfma_f32_32x32x16_bf16 v[96:111], v[48:51], v[220:223], v[96:111]
    ds_read_b64_tr_b16 v[40:41], v29 offset:17152
    ds_read_b64_tr_b16 v[42:43], v29 offset:19200
    v_mfma_f32_32x32x16_bf16 v[96:111], v[52:55], v[224:227], v[96:111]
    ds_read_b64_tr_b16 v[44:45], v29 offset:21248
    ds_read_b64_tr_b16 v[46:47], v29 offset:23296
    s_waitcnt lgkmcnt(8)
    v_mfma_f32_32x32x16_bf16 v[112:127], v[56:59], v[196:199], v[112:127]
    ds_read_b64_tr_b16 v[48:49], v29 offset:25344
    ds_read_b64_tr_b16 v[50:51], v29 offset:27392
    v_mfma_f32_32x32x16_bf16 v[112:127], v[60:63], v[200:203], v[112:127]
    ds_read_b64_tr_b16 v[52:53], v29 offset:29440
    ds_read_b64_tr_b16 v[54:55], v29 offset:31488
    s_nop 2
    v_cvt_pk_bf16_f32 v96, v96, v97
    v_cvt_pk_bf16_f32 v97, v98, v99
    v_cvt_pk_bf16_f32 v98, v100, v101
    v_cvt_pk_bf16_f32 v99, v102, v103
    buffer_store_dwordx4 v[96:99], v34, s[24:27], s5 offen offset:0 sc1
    s_waitcnt lgkmcnt(8)
    v_mfma_f32_32x32x16_bf16 v[112:127], v[2:5], v[204:207], v[112:127]
    ds_read_b64_tr_b16 v[56:57], v30 offset:16384
    ds_read_b64_tr_b16 v[58:59], v30 offset:18432
    v_cvt_pk_bf16_f32 v100, v104, v105
    v_cvt_pk_bf16_f32 v101, v106, v107
    v_cvt_pk_bf16_f32 v102, v108, v109
    v_cvt_pk_bf16_f32 v103, v110, v111
    buffer_store_dwordx4 v[100:103], v34, s[24:27], s5 offen offset:1024 sc1
    v_mfma_f32_32x32x16_bf16 v[112:127], v[6:9], v[208:211], v[112:127]
    ds_read_b64_tr_b16 v[60:61], v30 offset:20480
    ds_read_b64_tr_b16 v[62:63], v30 offset:22528
    s_waitcnt lgkmcnt(8)
    v_mfma_f32_32x32x16_bf16 v[112:127], v[40:43], v[212:215], v[112:127]
    ds_read_b64_tr_b16 v[2:3], v30 offset:24576
    ds_read_b64_tr_b16 v[4:5], v30 offset:26624
    v_mfma_f32_32x32x16_bf16 v[112:127], v[44:47], v[216:219], v[112:127]
    ds_read_b64_tr_b16 v[6:7], v30 offset:28672
    ds_read_b64_tr_b16 v[8:9], v30 offset:30720
    s_waitcnt lgkmcnt(8)
    v_mfma_f32_32x32x16_bf16 v[112:127], v[48:51], v[220:223], v[112:127]
    ds_read_b64_tr_b16 v[40:41], v29 offset:32768
    ds_read_b64_tr_b16 v[42:43], v29 offset:34816
    v_mfma_f32_32x32x16_bf16 v[112:127], v[52:55], v[224:227], v[112:127]
    ds_read_b64_tr_b16 v[44:45], v29 offset:36864
    ds_read_b64_tr_b16 v[46:47], v29 offset:38912
    s_waitcnt lgkmcnt(8)
    v_mfma_f32_32x32x16_bf16 v[64:79], v[56:59], a[64:67], v[64:79]
    ds_read_b64_tr_b16 v[48:49], v29 offset:40960
    ds_read_b64_tr_b16 v[50:51], v29 offset:43008
    v_mfma_f32_32x32x16_bf16 v[64:79], v[60:63], a[68:71], v[64:79]
    ds_read_b64_tr_b16 v[52:53], v29 offset:45056
    ds_read_b64_tr_b16 v[54:55], v29 offset:47104
    s_nop 2
    v_cvt_pk_bf16_f32 v112, v112, v113
    v_cvt_pk_bf16_f32 v113, v114, v115
    v_cvt_pk_bf16_f32 v114, v116, v117
    v_cvt_pk_bf16_f32 v115, v118, v119
    buffer_store_dwordx4 v[112:115], v34, s[24:27], s6 offen offset:0 sc1
    s_waitcnt lgkmcnt(8)
    v_mfma_f32_32x32x16_bf16 v[64:79], v[2:5], a[72:75], v[64:79]
    ds_read_b64_tr_b16 v[56:57], v29 offset:0
    ds_read_b64_tr_b16 v[58:59], v29 offset:2048
    v_cvt_pk_bf16_f32 v116, v120, v121
    v_cvt_pk_bf16_f32 v117, v122, v123
    v_cvt_pk_bf16_f32 v118, v124, v125
    v_cvt_pk_bf16_f32 v119, v126, v127
    buffer_store_dwordx4 v[116:119], v34, s[24:27], s6 offen offset:1024 sc1
    v_mfma_f32_32x32x16_bf16 v[64:79], v[6:9], a[76:79], v[64:79]
    ds_read_b64_tr_b16 v[60:61], v29 offset:4096
    ds_read_b64_tr_b16 v[62:63], v29 offset:6144
    s_mov_b32 s60, 0
    s_mul_i32 s54, s48, 24576
    s_add_u32 s54, s54, s62
    s_add_u32 s99, s54, 4096
    s_waitcnt lgkmcnt(8)
    v_mfma_f32_32x32x16_bf16 v[64:79], v[40:43], a[80:83], v[64:79]
    ds_read_b64_tr_b16 v[2:3], v29 offset:8192
    ds_read_b64_tr_b16 v[4:5], v29 offset:10240
    v_mfma_f32_32x32x16_bf16 v[64:79], v[44:47], a[84:87], v[64:79]
    ds_read_b64_tr_b16 v[6:7], v29 offset:12288
    ds_read_b64_tr_b16 v[8:9], v29 offset:14336
    s_waitcnt lgkmcnt(8)
    v_mfma_f32_32x32x16_bf16 v[64:79], v[48:51], a[88:91], v[64:79]
    ds_read_b64_tr_b16 v[40:41], v30 offset:0
    ds_read_b64_tr_b16 v[42:43], v30 offset:2048
    v_mfma_f32_32x32x16_bf16 v[64:79], v[52:55], a[92:95], v[64:79]
    ds_read_b64_tr_b16 v[44:45], v30 offset:4096
    ds_read_b64_tr_b16 v[46:47], v30 offset:6144
    s_waitcnt lgkmcnt(8)
    v_mfma_f32_32x32x16_bf16 v[64:79], v[56:59], a[96:99], v[64:79]
    ds_read_b64_tr_b16 v[48:49], v30 offset:8192
    ds_read_b64_tr_b16 v[50:51], v30 offset:10240
    v_mfma_f32_32x32x16_bf16 v[64:79], v[60:63], a[100:103], v[64:79]
    ds_read_b64_tr_b16 v[52:53], v30 offset:12288
    ds_read_b64_tr_b16 v[54:55], v30 offset:14336
    s_waitcnt lgkmcnt(8)
    v_mfma_f32_32x32x16_bf16 v[64:79], v[2:5], a[104:107], v[64:79]
    ds_read_b64_tr_b16 v[56:57], v29 offset:16384
    ds_read_b64_tr_b16 v[58:59], v29 offset:18432
    v_mfma_f32_32x32x16_bf16 v[64:79], v[6:9], a[108:111], v[64:79]
    ds_read_b64_tr_b16 v[60:61], v29 offset:20480
    ds_read_b64_tr_b16 v[62:63], v29 offset:22528
    s_waitcnt lgkmcnt(8)
    v_mfma_f32_32x32x16_bf16 v[128:143], v[40:43], v[196:199], 0
    ds_read_b64_tr_b16 v[2:3], v29 offset:24576
    ds_read_b64_tr_b16 v[4:5], v29 offset:26624
    v_mfma_f32_32x32x16_bf16 v[128:143], v[44:47], v[200:203], v[128:143]
    ds_read_b64_tr_b16 v[6:7], v29 offset:28672
    ds_read_b64_tr_b16 v[8:9], v29 offset:30720
    s_waitcnt lgkmcnt(8)
    v_mfma_f32_32x32x16_bf16 v[128:143], v[48:51], v[204:207], v[128:143]
    v_mfma_f32_32x32x16_bf16 v[128:143], v[52:55], v[208:211], v[128:143]
    s_waitcnt lgkmcnt(4)
    v_mfma_f32_32x32x16_bf16 v[128:143], v[56:59], v[212:215], v[128:143]
    v_mfma_f32_32x32x16_bf16 v[128:143], v[60:63], v[216:219], v[128:143]
    s_waitcnt lgkmcnt(0)
    v_mfma_f32_32x32x16_bf16 v[128:143], v[2:5], v[220:223], v[128:143]
    v_mfma_f32_32x32x16_bf16 v[128:143], v[6:9], v[224:227], v[128:143]
    v_pk_add_f32 v[64:65], v[64:65], v[228:229]
    v_pk_add_f32 v[66:67], v[66:67], v[230:231]
    v_pk_add_f32 v[68:69], v[68:69], v[232:233]
    v_pk_add_f32 v[70:71], v[70:71], v[234:235]
    v_pk_add_f32 v[72:73], v[72:73], v[236:237]
    v_pk_add_f32 v[74:75], v[74:75], v[238:239]
    v_pk_add_f32 v[76:77], v[76:77], v[240:241]
    v_pk_add_f32 v[78:79], v[78:79], v[242:243]
    s_waitcnt vmcnt(0)
    s_atomic_add s0, s[24:25], s61
    s_mov_b32 s52, 0
    s_atomic_umax s52, s[24:25], s61 glc
    v_pk_fma_f32 v[64:65], v[64:65], v[244:245], v[128:129] op_sel_hi:[1,0,1]
    v_pk_fma_f32 v[66:67], v[66:67], v[244:245], v[130:131] op_sel_hi:[1,0,1]
    v_pk_fma_f32 v[68:69], v[68:69], v[244:245], v[132:133] op_sel_hi:[1,0,1]
    v_pk_fma_f32 v[70:71], v[70:71], v[244:245], v[134:135] op_sel_hi:[1,0,1]
    v_pk_fma_f32 v[72:73], v[72:73], v[244:245], v[136:137] op_sel_hi:[1,0,1]
    v_pk_fma_f32 v[74:75], v[74:75], v[244:245], v[138:139] op_sel_hi:[1,0,1]
    v_pk_fma_f32 v[76:77], v[76:77], v[244:245], v[140:141] op_sel_hi:[1,0,1]
    v_pk_fma_f32 v[78:79], v[78:79], v[244:245], v[142:143] op_sel_hi:[1,0,1]
    s_bfe_u32 s37, s52, 0x80000
    s_cmp_ge_u32 s37, 4
    s_cbranch_scc1 LQ_gd32
LQ_g31:
    s_waitcnt lgkmcnt(0)
    s_bfe_u32 s37, s52, 0x80000
    s_cmp_ge_u32 s37, 4
    s_cbranch_scc1 LQ_gd32
LQ_ga33:
    s_cmp_eq_u32 s98, 0
    s_cbranch_scc1 LQ_gd32
    s_sub_u32 s98, s98, 1
    s_atomic_umax s52, s[24:25], s61 glc
    s_branch LQ_g31
LQ_gd32:
    buffer_load_dwordx4 v[160:163], v34, s[24:27], s54 offen offset:0 sc1
    buffer_load_dwordx4 v[164:167], v34, s[24:27], s54 offen offset:1024 sc1
    buffer_load_dwordx4 v[168:171], v34, s[24:27], s54 offen offset:2048 sc1
    buffer_load_dwordx4 v[172:175], v34, s[24:27], s54 offen offset:3072 sc1
    buffer_load_dwordx4 v[176:179], v34, s[24:27], s99 offen offset:0 sc1
    buffer_load_dwordx4 v[180:183], v34, s[24:27], s99 offen offset:1024 sc1
    s_waitcnt vmcnt(5)
    v_mfma_f32_32x32x16_bf16 v[80:95], v[188:191], v[160:163], v[64:79]
    s_waitcnt vmcnt(4)
    v_mfma_f32_32x32x16_bf16 v[80:95], v[192:195], v[164:167], v[80:95]
    s_waitcnt vmcnt(3)
    v_mfma_f32_32x32x16_bf16 v[80:95], v[188:191], v[168:171], v[80:95]
    s_waitcnt vmcnt(2)
    v_mfma_f32_32x32x16_bf16 v[80:95], v[192:195], v[172:175], v[80:95]
    s_waitcnt vmcnt(1)
    v_mfma_f32_32x32x16_bf16 v[80:95], v[188:191], v[176:179], v[80:95]
    s_waitcnt vmcnt(0)
    v_mfma_f32_32x32x16_bf16 v[80:95], v[192:195], v[180:183], v[80:95]
    s_nop 11
    v_cvt_pk_bf16_f32 v160, v80, v81
    v_cvt_pk_bf16_f32 v161, v82, v83
    ds_write_b64 v18, v[160:161] offset:0
    v_cvt_pk_bf16_f32 v162, v84, v85
    v_cvt_pk_bf16_f32 v163, v86, v87
    ds_write_b64 v18, v[162:163] offset:16
    v_cvt_pk_bf16_f32 v164, v88, v89
    v_cvt_pk_bf16_f32 v165, v90, v91
    ds_write_b64 v18, v[164:165] offset:32
    v_cvt_pk_bf16_f32 v166, v92, v93
    v_cvt_pk_bf16_f32 v167, v94, v95
    ds_write_b64 v18, v[166:167] offset:48
    ds_read_b128 v[168:171], v19 offset:0
    ds_read_b128 v[172:175], v19 offset:1280
    s_waitcnt lgkmcnt(1)
    buffer_store_dwordx4 v[168:171], v20, s[28:31], s40 offen
    s_waitcnt lgkmcnt(0)
    buffer_store_dwordx4 v[172:175], v20, s[28:31], s41 offen
    s_endpgm
LQ_i1:
    s_waitcnt lgkmcnt(0)
    s_cmp_ge_u32 s97, 32
    s_cbranch_scc1 LQ_id2
    s_cmp_eq_u32 s98, 0
    s_cbranch_scc1 LQ_id2
    s_sub_u32 s98, s98, 1
    s_sleep 8
    s_mov_b32 s97, 0
    s_atomic_add s97, s[40:41], 0x0 glc
    s_branch LQ_i1
L_end:
    s_endpgm
.section .rodata,"a"
.p2align 6
.amdhsa_kernel gated_mix__linear_attn_block__dense_activation_squared_relu__prompt_kernel
  .amdhsa_next_free_vgpr 512
  .amdhsa_next_free_sgpr 102
  .amdhsa_accum_offset 256
  .amdhsa_group_segment_fixed_size 0
  .amdhsa_kernarg_size 96
  .amdhsa_user_sgpr_count 2
  .amdhsa_user_sgpr_kernarg_segment_ptr 1
  .amdhsa_system_sgpr_workgroup_id_x 1
  .amdhsa_float_denorm_mode_32 3
  .amdhsa_float_denorm_mode_16_64 3
.end_amdhsa_kernel
```
